```python
import torch

def _softmax(x, axis=-1):
    return torch.softmax(x, dim=axis)
def _gelu(x):
    return torch.nn.functional.gelu(x, approximate="tanh")
def _silu(x):
    return torch.nn.functional.silu(x)
def _sigmoid(x):
    return torch.sigmoid(x)
def _layernorm(x, axis=-1, eps=1e-5):
    m = x.mean(dim=axis, keepdim=True)
    v = x.var(dim=axis, keepdim=True, unbiased=False)
    return (x - m) / torch.sqrt(v + eps)
def _scatter_add(tgt, idx, src, axis=0):
    return tgt.clone().index_add_(axis, idx, src)
def _segment_sum(src, seg, n):
    out = torch.zeros((n,) + src.shape[1:], dtype=src.dtype)
    return out.index_add_(0, seg, src)
def _pad(x, pw):
    flat = tuple(v for pair in reversed(pw) for v in pair)
    return torch.nn.functional.pad(x, flat)

kernel_name = 'standalone__deep_cross_xdeepfm__recsys'

def setup_inputs():

    _w = (lambda a: (lambda t: t.to(torch.bfloat16) if t.is_floating_point() else t)(torch.as_tensor(a)))
    B, F, D, L = 4096, 26, 32, 3
    V = min(100000, 100000)
    Din = F * D
    return {
        "idx": _w((lambda lo, hi, *s: torch.randint(lo, hi, s))(0, V, B, F).to(torch.int64)),
        "table": _w((lambda *s: torch.randn(*s, dtype=torch.bfloat16) * 0.8)(V, D)),
        "ws_cin": _w((lambda *s: torch.randn(*s, dtype=torch.bfloat16) * 0.2)(L, F, F, F) * (1.0 / F)),
        "w_cin_out": _w((lambda *s: torch.randn(*s, dtype=torch.bfloat16) * 0.2)(L * F) * ((L * F) ** -0.5)),
        "w_dnn1": _w((lambda *s: torch.randn(*s, dtype=torch.bfloat16) * 0.8)(Din, Din) * (Din ** -0.5)),
        "b_dnn1": _w((lambda *s: torch.randn(*s, dtype=torch.bfloat16) * 1.6)(Din) * 0.1),
        "w_dnn2": _w((lambda *s: torch.randn(*s, dtype=torch.bfloat16) * 0.2)(Din) * (Din ** -0.5)),
        "b_out": _w((lambda *s: torch.randn(*s, dtype=torch.bfloat16) * 0.2)(1)),
    }

def reference(idx, table, ws_cin, w_cin_out, w_dnn1, b_dnn1, w_dnn2, b_out):
    x0 = table[idx]
    B = x0.shape[0]
    L = ws_cin.shape[0]
    xk = x0
    pooled = []
    for l in range(L):
        xk = torch.einsum('bid,bjd,hij->bhd', xk, x0, ws_cin[l])
        pooled.append(xk.sum(axis=-1))
    p_plus = torch.stack(pooled, axis=1).reshape(B, -1)
    logit_cin = p_plus @ w_cin_out
    h = x0.reshape(B, -1)
    h = _gelu(h @ w_dnn1 + b_dnn1)
    logit_dnn = h @ w_dnn2
    return logit_cin + logit_dnn + b_out
```

```asm
; @launch grid=(256,1,1) block=(512,1,1) lds=163840
.amdgcn_target "amdgcn-amd-amdhsa--gfx950"
.text
.p2align 12
.globl standalone__deep_cross_xdeepfm__recsys_kernel
.p2align 8
.type standalone__deep_cross_xdeepfm__recsys_kernel,@function
standalone__deep_cross_xdeepfm__recsys_kernel:
    s_cmp_ge_u32 s2, 256
    s_cbranch_scc1 L_end
    s_load_dwordx16 s[4:19], s[0:1], 0
    s_load_dwordx4 s[20:23], s[0:1], 64
    s_load_dwordx2 s[24:25], s[0:1], 80
    v_lshrrev_b32 v1, 6, v0
    v_and_b32 v0, 63, v0
    s_lshr_b32 s28, s2, 3
    v_readfirstlane_b32 s26, v1
    s_getpc_b64 s[64:65]
L_pfbase:
    s_cmp_lg_u32 s26, 0
    s_cbranch_scc1 L_nopf
    s_mul_i32 s66, s28, 1152
    v_min_u32 v2, 8, v0
    v_lshl_add_u32 v2, v2, 7, s66
    v_min_u32 v2, L_codeend-L_pfbase-4, v2
    global_load_dword v255, v2, s[64:65]
L_nopf:
    s_and_b32 s27, s2, 7
    s_and_b32 s30, s28, 3
    s_bfe_u32 s29, s28, 0x20002
    s_lshl_b32 s64, s27, 2
    s_add_u32 s29, s29, s64
    v_lshlrev_b32 v2, 4, v0
    v_lshlrev_b32 v251, 7, v0
    s_cmp_ge_u32 s28, 16
    s_cbranch_scc1 L_cin
    s_cmp_ge_u32 s26, 4
    s_cbranch_scc1 L_comp
    s_and_b32 s66, s26, 3
    s_lshl_b32 s64, s29, 2
    s_add_u32 s64, s64, s66
    s_mul_i32 s64, s64, 3328
    s_mul_i32 s67, s66, 3328
    s_add_u32 s67, s67, 129024
    s_mov_b32 m0, s67
    s_lshl_b32 s65, s66, 4
    s_add_u32 s65, s65, s28
    s_lshl_b32 s65, s65, 13
    s_waitcnt lgkmcnt(0)
    s_mov_b32 s32, s4
    s_mov_b32 s33, s5
    s_mov_b32 s34, 425984
    s_mov_b32 s35, 0x20000
    buffer_load_dwordx4 v2, s[32:35], s64 offen offset:0 lds
    buffer_load_dwordx4 v2, s[32:35], s64 offen offset:1024 lds
    buffer_load_dwordx4 v2, s[32:35], s64 offen offset:2048 lds
    s_mov_b64 exec, 0xffff
    buffer_load_dwordx4 v2, s[32:35], s64 offen offset:3072 lds
    s_mov_b64 exec, -1
    s_mov_b32 s40, s12
    s_mov_b32 s41, s13
    s_mov_b32 s42, 1384448
    s_mov_b32 s43, 0x20000
    s_mov_b32 s60, s65
    s_cmp_lg_u32 s66, 3
    s_cbranch_scc1 L_loader
    s_lshl_b32 s64, s28, 13
    s_mov_b32 s48, s8
    s_mov_b32 s49, s9
    s_mov_b32 s50, 105456
    s_mov_b32 s51, 0x20000
    buffer_load_dword v35, v251, s[48:51], s64 offen
    s_branch L_loader
L_cin:
    s_sub_u32 s31, s28, 16
    s_lshl_b32 s3, s26, 10
    v_lshlrev_b32 v6, 2, v0
    s_lshl_b32 s64, s29, 3
    s_lshl_b32 s65, s30, 1
    s_add_u32 s64, s64, s65
    s_sub_u32 s65, s26, 5
    s_add_u32 s64, s64, s65
    s_mul_i32 s66, s64, 1664
    s_mul_i32 s65, s65, 3328
    s_add_u32 s67, s65, 27904
    s_lshl_b32 s68, s31, 13
    s_sub_u32 s101, s3, 2048
    v_bfe_u32 v23, v0, 2, 1
    v_bfe_u32 v22, v0, 3, 1
    v_lshl_add_u32 v14, v22, 4, v23
    v_bfe_u32 v22, v0, 4, 1
    v_lshl_add_u32 v14, v22, 1, v14
    v_and_b32 v13, 3, v0
    v_lshl_add_u32 v14, v13, 2, v14
    v_add_u32 v14, 52, v14
    v_bfe_u32 v15, v0, 2, 3
    v_lshl_add_u32 v15, v13, 3, v15
    v_cmp_gt_u32 vcc, 26, v15
    v_add_u32 v15, 26, v15
    v_mov_b32 v21, 0
    v_cndmask_b32 v15, -16, v15, vcc
    v_cmp_gt_u32 vcc, 32, v0
    v_lshrrev_b32 v1, 5, v0
    v_and_b32 v7, 15, v0
    v_cndmask_b32 v14, v15, v14, vcc
    v_lshlrev_b32 v36, 1, v14
    s_waitcnt lgkmcnt(0)
    s_mov_b32 s48, s8
    s_mov_b32 s49, s9
    s_mov_b32 s50, 105456
    s_mov_b32 s51, 0x20000
    s_cmp_eq_u32 s26, 1
    s_cbranch_scc1 L_c3
    s_cmp_ge_u32 s101, 3072
    s_cbranch_scc1 L_c2
    s_add_u32 m0, s101, 160096
    s_add_u32 s64, s101, 103072
    buffer_load_dwordx4 v2, s[48:51], s64 offen lds
    s_branch L_c4
L_c2:
    s_bitcmp1_b32 0x60, s26
    s_cbranch_scc0 L_c4
    s_mov_b32 m0, s67
    s_mov_b32 s32, s4
    s_mov_b32 s33, s5
    s_mov_b32 s34, 425984
    s_mov_b32 s35, 0x20000
    buffer_load_dwordx4 v2, s[32:35], s66 offen lds
    buffer_load_dwordx4 v2, s[32:35], s66 offen offset:1024 lds
    s_branch L_c4
L_c3:
    s_mov_b32 s96, s10
    s_mov_b32 s97, s11
    s_mov_b32 s98, 156
    s_mov_b32 s99, 0x20000
    buffer_load_ushort v20, v36, s[96:99], 0 offen
L_c4:
    s_mov_b32 s60, s66
    s_mov_b32 s61, s67
    s_add_u32 m0, s3, 127328
    s_add_u32 s64, s3, 70304
    buffer_load_dwordx4 v2, s[48:51], s64 offen lds
    s_add_u32 m0, s3, 135520
    s_add_u32 s64, s3, 78496
    buffer_load_dwordx4 v2, s[48:51], s64 offen lds
    s_add_u32 m0, s3, 143712
    s_add_u32 s64, s3, 86688
    buffer_load_dwordx4 v2, s[48:51], s64 offen lds
    s_add_u32 m0, s3, 151904
    s_add_u32 s64, s3, 94880
    buffer_load_dwordx4 v2, s[48:51], s64 offen lds
    v_mov_b32 v3, 0
    v_lshrrev_b32 v5, 4, v0
    v_lshlrev_b32 v38, 4, v5
    v_add_u32 v38, 126336, v38
    v_lshl_add_u32 v8, v1, 4, v7
    v_min_u32 v8, 25, v8
    v_xor_b32 v37, 1, v1
    v_mul_u32_u24 v37, 160, v37
    v_lshl_add_u32 v37, v0, 1, v37
    v_add_u32 v37, 126176, v37
    v_mov_b32 v247, 0
    v_bfe_u32 v23, v0, 2, 2
    v_lshlrev_b32 v13, 3, v13
    s_cmp_lg_u32 s26, 7
    s_cbranch_scc1 L_c11
    v_lshlrev_b32 v9, 1, v8
    s_mov_b32 s96, s10
    s_mov_b32 s97, s11
    s_mov_b32 s98, 156
    s_mov_b32 s99, 0x20000
    buffer_load_short_d16_hi v21, v9, s[96:99], 0 offen
L_c11:
    v_lshlrev_b32 v4, 2, v23
    v_lshl_add_u32 v4, v22, 4, v4
    v_lshl_add_u32 v4, v1, 1, v4
    v_subrev_u32 v15, 22, v4
    v_max_i32 v15, 0, v15
    v_and_b32 v15, -4, v15
    v_sub_u32 v4, v4, v15
    v_mul_u32_u24 v4, 1352, v4
    s_and_b32 s65, s26, 1
    s_mul_i32 s64, s26, 52
    s_lshl_b32 s67, s65, 2
    s_sub_u32 s64, s64, s67
    s_add_u32 s64, s64, 127328
    v_add3_u32 v10, v4, v13, s64
    s_mul_i32 s67, s65, 160
    s_lshl_b32 s64, s26, 3
    s_sub_u32 s64, s64, s67
    s_add_u32 s64, s64, 124160
    v_mul_u32_u24 v32, 80, v7
    v_add_u32 v32, s64, v32
    s_cmp_eq_u32 s65, 0
    s_cselect_b32 s68, 0, 3
    s_xor_b32 s68, s68, 0xffff
    s_cmp_eq_u32 s65, 0
    s_cselect_b32 s27, 0x3ff, 0
    s_cselect_b32 s65, 0, 0xfff
    s_or_b32 s27, s27, s65
    s_mov_b32 s36, s6
    s_mov_b32 s37, s7
    s_mov_b32 s38, 6400000
    s_mov_b32 s39, 0x20000
    s_mov_b32 s40, s12
    s_mov_b32 s41, s13
    s_mov_b32 s42, 1384448
    s_mov_b32 s43, 0x20000
    v_lshlrev_b32 v4, 3, v23
    v_lshl_add_u32 v4, v1, 1, v4
    v_lshl_add_u32 v15, v22, 5, v13
    s_mul_i32 s64, s26, 104
    s_add_u32 s64, s64, 88656
    v_subrev_u32 v14, 8, v4
    v_cmp_gt_u32 vcc, 26, v4
    v_min_u32 v42, 2, v23
    v_lshlrev_b32 v42, 3, v42
    v_cndmask_b32 v14, v14, v4, vcc
    v_lshl_add_u32 v42, v1, 1, v42
    v_mul_u32_u24 v14, 1352, v14
    v_add3_u32 v40, v14, v15, s64
    v_mul_u32_u24 v42, 1352, v42
    s_add_u32 s64, s64, 5408
    v_add3_u32 v42, v42, v15, s64
    v_and_b32 v4, 31, v0
    v_min_u32 v44, 26, v4
    v_mul_u32_u24 v44, 80, v44
    v_lshl_add_u32 v44, v1, 4, v44
    v_add_u32 v44, 124160, v44
    v_mul_u32_u24 v15, 52, v4
    v_add_u32 v15, 127332, v15
    v_mov_b32 v14, 162484
    v_cmp_gt_u32 vcc, 26, v4
    v_mov_b32 v24, 104
    v_mov_b32 v25, 2704
    v_cndmask_b32 v15, v14, v15, vcc
    v_cndmask_b32 v14, v24, v25, vcc
    v_subrev_u32 v24, 16, v4
    v_lshl_add_u32 v15, v1, 3, v15
    v_cndmask_b32 v24, v24, v4, vcc
    s_add_u32 s67, s26, 8
    s_min_u32 s67, s67, 12
    v_mad_u32_u24 v46, v14, s26, v15
    v_mad_u32_u24 v48, v14, s67, v15
    v_lshrrev_b32 v14, 1, v14
    v_add3_u32 v47, v46, v14, -4
    v_add3_u32 v49, v48, v14, -4
    s_sub_u32 s67, s67, s26
    s_mul_i32 s67, s67, 104
    v_mul_u32_u24 v25, 1488, v24
    v_lshl_add_u32 v25, v1, 4, v25
    v_add_u32 v215, 88656, v25
    s_mul_i32 s100, s26, 3328
    s_add_u32 s100, s100, 128
    v_lshl_add_u32 v4, v4, 1, s100
    v_lshl_add_u32 v212, v1, 7, v4
    v_xor_b32 v14, 1, v1
    v_lshl_add_u32 v214, v14, 7, v4
    v_lshl_add_u32 v213, v14, 8, v214
    v_lshl_add_u32 v4, v1, 2, v23
    v_lshlrev_b32 v4, 3, v4
    v_lshl_add_u32 v14, v22, 5, v13
    v_add_u32 v15, s100, v14
    v_cmp_eq_u32 vcc, 1, v23
    s_mov_b32 s64, 0x7020500
    s_mov_b32 s65, 0x4030601
    v_lshrrev_b64 v[28:29], v4, s[64:65]
    v_and_b32 v28, 0xff, v28
    v_lshl_add_u32 v208, v28, 7, v15
    s_mov_b32 s64, 0xf0a0d08
    s_mov_b32 s65, 0xc0b0e09
    v_lshrrev_b64 v[28:29], v4, s[64:65]
    v_and_b32 v28, 0xff, v28
    v_lshl_add_u32 v209, v28, 7, v15
    s_mov_b32 s64, 0x17121510
    s_mov_b32 s65, 0x14131611
    v_lshrrev_b64 v[28:29], v4, s[64:65]
    v_and_b32 v28, 0xff, v28
    v_lshl_add_u32 v210, v28, 7, v15
    s_mov_b32 s64, 0x3011a18
    s_mov_b32 s65, 0x21a19
    v_lshrrev_b64 v[28:29], v4, s[64:65]
    v_and_b32 v28, 0xff, v28
    v_lshl_add_u32 v211, v28, 7, v15
    v_cndmask_b32 v211, v211, v14, vcc
    v_mul_u32_u24 v50, 1352, v8
    v_mul_u32_u24 v15, 73828, v22
    v_add_u32 v50, v50, v15
    v_add_u32 v50, 53504, v50
    v_mul_u32_u24 v51, 52, v8
    v_add_u32 v51, 162484, v51
    v_mul_u32_u24 v52, 1488, v8
    v_lshl_add_u32 v52, v22, 5, v52
    v_add_u32 v52, 88656, v52
    v_and_b32 v15, 1, v23
    v_lshl_add_u32 v15, v15, 3, s26
    v_mul_u32_u24 v15, 104, v15
    v_and_b32 v14, 3, v0
    v_lshlrev_b32 v252, 4, v14
    v_lshrrev_b32 v4, 3, v0
    v_lshl_add_u32 v24, v4, 2, v15
    v_add_u32 v24, 16, v24
    v_lshl_add_u32 v25, v4, 2, v15
    v_add_u32 v25, 48, v25
    v_add_u32 v14, 20, v4
    v_subrev_u32 v28, 26, v14
    v_min_u32 v14, v14, v28
    v_lshl_add_u32 v26, v14, 2, v15
    v_lshl_add_u32 v27, v4, 2, v15
    v_add_u32 v27, 8, v27
    v_mov_b64 v[64:65], 0
    v_mov_b64 v[66:67], 0
    v_mov_b64 v[68:69], 0
    v_mov_b64 v[70:71], 0
    v_mov_b64 v[72:73], 0
    v_mov_b64 v[74:75], 0
    v_mov_b64 v[76:77], 0
    v_mov_b64 v[78:79], 0
    v_mov_b64 v[80:81], 0
    v_mov_b64 v[82:83], 0
    v_mov_b64 v[84:85], 0
    v_mov_b64 v[86:87], 0
    v_mov_b64 v[88:89], 0
    v_mov_b64 v[90:91], 0
    v_mov_b64 v[92:93], 0
    v_mov_b64 v[94:95], 0
    v_mov_b64 v[216:217], 0
    v_mov_b64 v[218:219], 0
    v_mov_b64 v[220:221], 0
    v_mov_b64 v[222:223], 0
    v_mov_b64 v[224:225], 0
    v_mov_b64 v[226:227], 0
    v_mov_b64 v[228:229], 0
    v_mov_b64 v[230:231], 0
    v_mov_b64 v[236:237], 0
    v_mov_b64 v[238:239], 0
    s_lshl_b32 s64, s26, 4
    s_add_u32 s64, s64, s31
    s_add_u32 s64, s64, 48
    s_lshl_b32 s69, s64, 13
    s_mov_b32 s44, s24
    s_mov_b32 s45, s25
    s_mov_b32 s46, 131072
    s_mov_b32 s47, 0x20000
    s_mov_b32 s52, s22
    s_mov_b32 s53, s23
    s_mov_b32 s54, 256
    s_mov_b32 s55, 0x20000
    s_mov_b32 s56, s20
    s_mov_b32 s57, s21
    s_mov_b32 s58, 8192
    s_mov_b32 s59, 0x20000
    v_lshl_add_u32 v4, v22, 1, v1
    v_lshl_add_u32 v4, v4, 3, s26
    s_lshl_b32 s64, s30, 5
    v_add_u32 v4, s64, v4
    v_lshlrev_b32 v14, 2, v4
    v_lshl_add_u32 v14, v7, 9, v14
    s_lshl_b32 s64, s29, 12
    s_add_u32 s64, s64, 0
    v_add_u32 v14, s64, v14
    v_mov_b32 v15, 2146435072
    v_add_u32 v28, 126976, v14
    v_cmp_gt_u32 vcc, 8, v7
    s_lshl_b32 s64, s29, 8
    v_lshl_add_u32 v4, v4, 1, s64
    v_cndmask_b32 v244, v15, v14, vcc
    v_cmp_eq_u32 vcc, 0, v7
    s_nop 1
    v_cndmask_b32 v246, v15, v4, vcc
    v_and_b32 v33, 31, v0
    v_lshlrev_b32 v33, 2, v33
    v_mul_u32_u24 v14, 26752, v1
    v_add_u32 v33, v33, v14
    v_mov_b32 v34, 0x3f803f80
    ds_write_b32 v33, v34
    s_and_b32 s101, s3, 0xfff
    s_cmp_ge_u32 s26, 4
    s_cbranch_scc1 L_c7
    s_add_u32 m0, s101, 88320
    s_add_u32 s64, s101, 34816
    buffer_load_dwordx4 v2, s[48:51], s64 offen lds
    s_add_u32 m0, s101, 92416
    s_add_u32 s64, s101, 38912
    buffer_load_dwordx4 v2, s[48:51], s64 offen lds
    s_add_u32 m0, s101, 96512
    s_add_u32 s64, s101, 43008
    buffer_load_dwordx4 v2, s[48:51], s64 offen lds
    s_add_u32 m0, s101, 100608
    s_add_u32 s64, s101, 47104
    buffer_load_dwordx4 v2, s[48:51], s64 offen lds
    s_add_u32 m0, s101, 104704
    s_add_u32 s64, s101, 51200
    buffer_load_dwordx4 v2, s[48:51], s64 offen lds
    s_add_u32 m0, s101, 108800
    s_add_u32 s64, s101, 55296
    buffer_load_dwordx4 v2, s[48:51], s64 offen lds
    s_cmp_lg_u32 s26, 1
    s_cbranch_scc1 L_c12
    s_waitcnt vmcnt(10)
    ds_write_b16 v37, v20
L_c12:
    s_waitcnt vmcnt(6) lgkmcnt(0)
    s_branch L_c8
L_c7:
    s_waitcnt vmcnt(0) lgkmcnt(0)
    s_cmp_lg_u32 s26, 7
    s_cbranch_scc1 L_c8
    s_mov_b32 m0, 87296
    s_mov_b32 s64, 33792
    buffer_load_dwordx4 v2, s[48:51], s64 offen lds
L_c8:
    s_barrier
    ds_read_b128 v[16:19], v38
    ds_read_b64_tr_b16 v[96:97], v10 offset:0
    ds_read_b64_tr_b16 v[98:99], v10 offset:1352
    ds_read_b64_tr_b16 v[100:101], v10 offset:32
    ds_read_b64_tr_b16 v[102:103], v10 offset:1384
    ds_read_b64_tr_b16 v[104:105], v10 offset:416
    ds_read_b64_tr_b16 v[106:107], v10 offset:1768
    ds_read_b64_tr_b16 v[108:109], v10 offset:448
    ds_read_b64_tr_b16 v[110:111], v10 offset:1800
    ds_read_b64_tr_b16 v[112:113], v10 offset:832
    ds_read_b64_tr_b16 v[114:115], v10 offset:2184
    ds_read_b64_tr_b16 v[116:117], v10 offset:864
    ds_read_b64_tr_b16 v[118:119], v10 offset:2216
    s_cmp_ge_u32 s26, 4
    s_cbranch_scc1 L_v0
    s_add_u32 m0, s101, 112896
    s_add_u32 s64, s101, 59392
    buffer_load_dwordx4 v2, s[48:51], s64 offen lds
    s_add_u32 m0, s101, 116992
    s_add_u32 s64, s101, 63488
    buffer_load_dwordx4 v2, s[48:51], s64 offen lds
    s_mov_b32 s65, 67584
    s_cmp_lt_u32 s101, 3072
    s_cselect_b32 s64, s65, -3072
    s_add_u32 s64, s64, s101
    s_add_u32 m0, s64, 53504
    s_nop 0
    buffer_load_dwordx4 v2, s[48:51], s64 offen lds
L_v0:
    s_waitcnt lgkmcnt(10)
    v_mfma_f32_16x16x32_bf16 v[128:131], v[16:19], v[96:99], 0
    s_waitcnt lgkmcnt(8)
    v_mfma_f32_16x16x32_bf16 v[132:135], v[16:19], v[100:103], 0
    s_waitcnt lgkmcnt(6)
    v_mfma_f32_16x16x32_bf16 v[136:139], v[16:19], v[104:107], 0
    s_waitcnt lgkmcnt(4)
    v_mfma_f32_16x16x32_bf16 v[140:143], v[16:19], v[108:111], 0
    s_waitcnt lgkmcnt(2)
    v_mfma_f32_16x16x32_bf16 v[144:147], v[16:19], v[112:115], 0
    s_waitcnt lgkmcnt(0)
    v_mfma_f32_16x16x32_bf16 v[148:151], v[16:19], v[116:119], 0
    v_mov_b32 v152, 0
    v_mov_b32 v156, 0
    s_cmp_ge_u32 s26, 2
    s_cbranch_scc1 L_v1
    ds_read_b64_tr_b16 v[120:121], v10 offset:1248
    ds_read_b64_tr_b16 v[122:123], v10 offset:2600
    ds_read_b64_tr_b16 v[124:125], v10 offset:1280
    ds_read_b64_tr_b16 v[126:127], v10 offset:2632
    s_waitcnt lgkmcnt(2)
    v_mfma_f32_16x16x32_bf16 v[152:155], v[16:19], v[120:123], 0
    s_waitcnt lgkmcnt(0)
    v_mfma_f32_16x16x32_bf16 v[156:159], v[16:19], v[124:127], 0
    s_nop 4
L_v1:
    s_mov_b32 exec_hi, 0
    s_nop 0
    v_cvt_pk_bf16_f32 v96, v128, v136
    v_cvt_pk_bf16_f32 v97, v144, v152
    v_cvt_pk_bf16_f32 v98, v132, v140
    v_cvt_pk_bf16_f32 v99, v148, v156
    s_mov_b32 exec_lo, s68
    ds_write_b64 v32, v[96:97]
    s_mov_b32 exec_lo, s27
    ds_write_b64 v32, v[98:99] offset:1280
    s_mov_b64 exec, -1
    ds_read_b32 v56, v24 offset:27904
    ds_read_b32 v60, v24 offset:31232
    ds_read_b32 v57, v25 offset:27904
    ds_read_b32 v61, v25 offset:31232
    ds_read_b32 v58, v26 offset:27904
    ds_read_b32 v62, v26 offset:31232
    ds_read_b32 v59, v27 offset:27904
    ds_read_b32 v63, v27 offset:31232
    s_cmp_lt_u32 s26, 4
    s_cbranch_scc1 L_v9
    s_add_u32 m0, s101, 54528
    s_add_u32 s64, s101, 1024
    buffer_load_dwordx4 v2, s[48:51], s64 offen lds
    s_add_u32 m0, s101, 58624
    s_add_u32 s64, s101, 5120
    buffer_load_dwordx4 v2, s[48:51], s64 offen lds
    s_add_u32 m0, s101, 62720
    s_add_u32 s64, s101, 9216
    buffer_load_dwordx4 v2, s[48:51], s64 offen lds
    s_add_u32 m0, s101, 66816
    s_add_u32 s64, s101, 13312
    buffer_load_dwordx4 v2, s[48:51], s64 offen lds
    s_add_u32 m0, s101, 70912
    s_add_u32 s64, s101, 17408
    buffer_load_dwordx4 v2, s[48:51], s64 offen lds
    s_add_u32 m0, s101, 75008
    s_add_u32 s64, s101, 21504
    buffer_load_dwordx4 v2, s[48:51], s64 offen lds
    s_add_u32 m0, s101, 79104
    s_add_u32 s64, s101, 25600
    buffer_load_dwordx4 v2, s[48:51], s64 offen lds
    s_add_u32 m0, s101, 83200
    s_add_u32 s64, s101, 29696
    buffer_load_dwordx4 v2, s[48:51], s64 offen lds
    s_branch L_c9
L_v9:
    s_bitcmp1_b32 15, s26
    s_cbranch_scc0 L_c9
    s_waitcnt vmcnt(0)
L_c9:
    s_waitcnt lgkmcnt(0)
    s_barrier
L_ustage:
    ds_read_b128 v[96:99], v44
    ds_read_b128 v[100:103], v44 offset:32
    ds_read_b64_tr_b16 v[104:105], v40 offset:0
    ds_read_b64_tr_b16 v[106:107], v40 offset:1352
    ds_read_b64_tr_b16 v[108:109], v42 offset:0
    ds_read_b64_tr_b16 v[110:111], v42 offset:1352
    ds_read_b64_tr_b16 v[112:113], v40 offset:48
    ds_read_b64_tr_b16 v[114:115], v40 offset:1400
    ds_read_b64_tr_b16 v[116:117], v42 offset:48
    ds_read_b64_tr_b16 v[118:119], v42 offset:1400
    v_add_u32 v40, s67, v40
    v_add_u32 v42, s67, v42
    s_mov_b32 s66, 0x7ffffff
    s_mov_b32 s67, 0x7ffffff
    s_cmp_ge_u32 s26, 4
    s_cbranch_scc1 L_u0
L_u0:
    s_add_u32 m0, s100, 0
    v_lshl_add_u32 v56, v56, 6, v252
    buffer_load_dwordx4 v56, s[36:39], 0 offen lds
    s_add_u32 m0, s100, 26752
    v_lshl_add_u32 v60, v60, 6, v252
    buffer_load_dwordx4 v60, s[36:39], 0 offen lds
    s_waitcnt lgkmcnt(4)
    v_mfma_f32_32x32x16_bf16 v[128:143], v[104:107], v[96:99], 0
    v_mfma_f32_32x32x16_bf16 v[128:143], v[108:111], v[100:103], v[128:143]
    s_waitcnt lgkmcnt(0)
    v_mfma_f32_32x32x16_bf16 v[144:159], v[112:115], v[96:99], 0
    v_mfma_f32_32x32x16_bf16 v[144:159], v[116:119], v[100:103], v[144:159]
    s_bitcmp1_b32 0x2f, s26
    s_cbranch_scc0 L_u5
    ds_read_b64_tr_b16 v[176:177], v40 offset:0
    ds_read_b64_tr_b16 v[178:179], v40 offset:1352
    ds_read_b64_tr_b16 v[180:181], v42 offset:0
    ds_read_b64_tr_b16 v[182:183], v42 offset:1352
L_u5:
    s_bitcmp1_b32 0x4f, s26
    s_cbranch_scc0 L_u6
    ds_read_b64_tr_b16 v[184:185], v40 offset:48
    ds_read_b64_tr_b16 v[186:187], v40 offset:1400
    ds_read_b64_tr_b16 v[188:189], v42 offset:48
    ds_read_b64_tr_b16 v[190:191], v42 offset:1400
L_u6:
    s_nop 7
    v_cvt_pk_bf16_f32 v192, v128, v129
    v_cvt_pk_bf16_f32 v193, v130, v131
    v_cvt_pk_bf16_f32 v194, v132, v133
    v_cvt_pk_bf16_f32 v195, v134, v135
    v_cvt_pk_bf16_f32 v196, v136, v137
    v_cvt_pk_bf16_f32 v197, v138, v139
    v_cvt_pk_bf16_f32 v198, v140, v141
    s_mov_b64 exec, s[66:67]
    ds_write2_b32 v46, v192, v193 offset0:0 offset1:1
    ds_write2_b32 v46, v194, v195 offset0:4 offset1:5
    ds_write2_b32 v46, v196, v197 offset0:8 offset1:9
    s_mov_b32 exec_hi, 0
    ds_write_b32 v46, v198 offset:48
    s_mov_b64 exec, -1
    s_bitcmp1_b32 0x2f, s26
    s_cbranch_scc0 L_u1
    s_waitcnt lgkmcnt(4)
    v_mfma_f32_32x32x16_bf16 v[160:175], v[176:179], v[96:99], 0
    v_mfma_f32_32x32x16_bf16 v[160:175], v[180:183], v[100:103], v[160:175]
L_u1:
    s_bitcmp1_b32 0x4f, s26
    s_cbranch_scc0 L_u2
    s_waitcnt lgkmcnt(4)
    v_mfma_f32_32x32x16_bf16 v[128:143], v[184:187], v[96:99], 0
    v_mfma_f32_32x32x16_bf16 v[128:143], v[188:191], v[100:103], v[128:143]
L_u2:
    s_waitcnt lgkmcnt(4)
    s_add_u32 m0, s100, 3072
    v_lshl_add_u32 v59, v59, 6, v252
    s_mov_b64 exec, 0xffff
    buffer_load_dwordx4 v59, s[36:39], 0 offen lds
    s_mov_b64 exec, -1
    v_cvt_pk_bf16_f32 v200, v144, v145
    v_cvt_pk_bf16_f32 v201, v146, v147
    v_cvt_pk_bf16_f32 v202, v148, v149
    v_cvt_pk_bf16_f32 v203, v150, v151
    v_cvt_pk_bf16_f32 v204, v152, v153
    v_cvt_pk_bf16_f32 v205, v154, v155
    v_cvt_pk_bf16_f32 v206, v156, v157
    v_cvt_pk_bf16_f32 v207, v158, v159
    s_mov_b64 exec, s[66:67]
    ds_write2_b32 v47, v202, v203 offset0:4 offset1:5
    ds_write2_b32 v47, v204, v205 offset0:8 offset1:9
    s_mov_b32 exec_hi, 0
    ds_write2_b32 v47, v206, v207 offset0:12 offset1:13
    ds_write_b32 v47, v201 offset:4
    s_mov_b32 exec_lo, 0
    s_mov_b32 exec_hi, s67
    ds_write2_b32 v47, v200, v201 offset0:0 offset1:1
    s_mov_b64 exec, -1
    s_bitcmp1_b32 0x2f, s26
    s_cbranch_scc0 L_u3
    v_cvt_pk_bf16_f32 v192, v160, v161
    v_cvt_pk_bf16_f32 v193, v162, v163
    v_cvt_pk_bf16_f32 v194, v164, v165
    v_cvt_pk_bf16_f32 v195, v166, v167
    v_cvt_pk_bf16_f32 v196, v168, v169
    v_cvt_pk_bf16_f32 v197, v170, v171
    v_cvt_pk_bf16_f32 v198, v172, v173
    s_mov_b64 exec, s[66:67]
    ds_write2_b32 v48, v192, v193 offset0:0 offset1:1
    ds_write2_b32 v48, v194, v195 offset0:4 offset1:5
    ds_write2_b32 v48, v196, v197 offset0:8 offset1:9
    s_mov_b32 exec_hi, 0
    ds_write_b32 v48, v198 offset:48
    s_mov_b64 exec, -1
L_u3:
    s_bitcmp1_b32 0x4f, s26
    s_cbranch_scc0 L_u4
    v_cvt_pk_bf16_f32 v200, v128, v129
    v_cvt_pk_bf16_f32 v201, v130, v131
    v_cvt_pk_bf16_f32 v202, v132, v133
    v_cvt_pk_bf16_f32 v203, v134, v135
    v_cvt_pk_bf16_f32 v204, v136, v137
    v_cvt_pk_bf16_f32 v205, v138, v139
    v_cvt_pk_bf16_f32 v206, v140, v141
    v_cvt_pk_bf16_f32 v207, v142, v143
    s_mov_b64 exec, s[66:67]
    ds_write2_b32 v49, v202, v203 offset0:4 offset1:5
    ds_write2_b32 v49, v204, v205 offset0:8 offset1:9
    s_mov_b32 exec_hi, 0
    ds_write2_b32 v49, v206, v207 offset0:12 offset1:13
    ds_write_b32 v49, v201 offset:4
    s_mov_b32 exec_lo, 0
    s_mov_b32 exec_hi, s67
    ds_write2_b32 v49, v200, v201 offset0:0 offset1:1
    s_mov_b64 exec, -1
L_u4:
    s_waitcnt lgkmcnt(0)
    s_waitcnt vmcnt(3)
    s_barrier
    s_mov_b32 s66, 0x3f80
    s_mov_b32 s67, 0x3f800000
    s_cmp_eq_u32 s26, 0
    s_cbranch_scc1 L_fold0
    s_cmp_eq_u32 s26, 1
    s_cbranch_scc1 L_fold1
    s_cmp_eq_u32 s26, 2
    s_cbranch_scc1 L_fold2
    s_cmp_eq_u32 s26, 3
    s_cbranch_scc1 L_fold3
    s_cmp_eq_u32 s26, 4
    s_cbranch_scc1 L_fold4
    s_cmp_eq_u32 s26, 5
    s_cbranch_scc1 L_fold5
    s_cmp_eq_u32 s26, 6
    s_cbranch_scc1 L_fold6
L_fold7:
    ds_read_b32 v128, v50 offset:640
    ds_read_b32 v129, v50 offset:440
    ds_read_b32 v130, v50 offset:748
    ds_read_b32 v131, v50 offset:548
    ds_read_b32 v132, v50 offset:692
    ds_read_b32 v133, v50 offset:492
    ds_read_b32 v134, v50 offset:800
    ds_read_b32 v135, v50 offset:600
    ds_read_b32 v136, v50 offset:744
    ds_read_b32 v137, v50 offset:496
    ds_read_b32 v138, v50 offset:596
    ds_read_b32 v139, v50 offset:644
    ds_read_b32 v140, v50 offset:444
    ds_read_b32 v141, v50 offset:544
    ds_read_b32 v142, v50 offset:796
    ds_read_b32 v143, v50 offset:696
    s_setprio 3
    ds_read_b32 v146, v50 offset:240
    ds_read_b32 v147, v50 offset:840
    ds_read_b32 v148, v50 offset:348
    ds_read_b32 v149, v50 offset:948
    ds_read_b32 v150, v50 offset:892
    s_waitcnt lgkmcnt(13)
    v_dot2_f32_bf16 v164, v128, s66, 0
    v_dot2_f32_bf16 v165, v130, s66, 0
    v_dot2_f32_bf16 v166, v132, s67, 0
    v_dot2_f32_bf16 v167, v134, s67, 0
    v_dot2_f32_bf16 v164, v129, s66, v164
    v_dot2_f32_bf16 v165, v131, s66, v165
    v_dot2_f32_bf16 v166, v133, s67, v166
    v_dot2_f32_bf16 v167, v135, s67, v167
    s_add_u32 m0, s100, 1024
    v_lshl_add_u32 v57, v57, 6, v252
    buffer_load_dwordx4 v57, s[36:39], 0 offen lds
    ds_read_b32 v151, v50 offset:292
    ds_read_b32 v152, v50 offset:1000
    ds_read_b32 v153, v50 offset:400
    ds_read_b32 v154, v50 offset:944
    ds_read_b32 v155, v50 offset:296
    s_waitcnt lgkmcnt(14)
    v_dot2_f32_bf16 v168, v129, s67, 0
    v_dot2_f32_bf16 v169, v131, s67, 0
    v_dot2_f32_bf16 v170, v136, s67, 0
    v_dot2_f32_bf16 v171, v138, s66, 0
    v_dot2_f32_bf16 v168, v132, s66, v168
    v_dot2_f32_bf16 v169, v134, s66, v169
    v_dot2_f32_bf16 v170, v137, s66, v170
    v_dot2_f32_bf16 v171, v139, s67, v171
    v_cvt_pk_bf16_f32 v96, v164, v165
    v_cvt_pk_bf16_f32 v100, v166, v167
    ds_read_b32 v156, v50 offset:844
    ds_read_b32 v157, v50 offset:396
    ds_read_b32 v158, v50 offset:244
    ds_read_b32 v159, v50 offset:344
    ds_read_b32 v160, v50 offset:996
    s_waitcnt lgkmcnt(15)
    v_dot2_f32_bf16 v164, v140, s66, 0
    v_dot2_f32_bf16 v165, v139, s66, 0
    v_dot2_f32_bf16 v166, v142, s67, 0
    v_dot2_f32_bf16 v167, v138, s67, 0
    v_dot2_f32_bf16 v164, v136, s66, v164
    v_dot2_f32_bf16 v165, v141, s66, v165
    v_dot2_f32_bf16 v166, v137, s67, v166
    v_dot2_f32_bf16 v167, v143, s67, v167
    v_cvt_pk_bf16_f32 v97, v168, v169
    v_cvt_pk_bf16_f32 v101, v170, v171
    s_setprio 2
    ds_read_b32 v161, v50 offset:896
    s_waitcnt lgkmcnt(15)
    v_dot2_f32_bf16 v168, v140, s67, 0
    v_dot2_f32_bf16 v169, v143, s66, 0
    v_dot2_f32_bf16 v170, v133, s66, 0
    v_dot2_f32_bf16 v171, v135, s66, 0
    v_dot2_f32_bf16 v168, v142, s66, v168
    v_dot2_f32_bf16 v169, v141, s67, v169
    v_dot2_f32_bf16 v170, v128, s67, v170
    v_dot2_f32_bf16 v171, v130, s67, v171
    v_cvt_pk_bf16_f32 v98, v164, v165
    v_cvt_pk_bf16_f32 v102, v166, v167
    ds_read_b32 v128, v51 offset:40
    ds_read_b32 v129, v51 offset:48
    ds_read_b32 v130, v51 offset:0
    ds_read_b32 v131, v51 offset:44
    ds_read_b32 v132, v51 offset:4
    s_waitcnt lgkmcnt(13)
    v_dot2_f32_bf16 v164, v146, s66, 0
    v_dot2_f32_bf16 v165, v148, s66, 0
    v_dot2_f32_bf16 v166, v150, s67, 0
    v_dot2_f32_bf16 v167, v152, s67, 0
    v_dot2_f32_bf16 v164, v147, s66, v164
    v_dot2_f32_bf16 v165, v149, s66, v165
    v_dot2_f32_bf16 v166, v151, s67, v166
    v_dot2_f32_bf16 v167, v153, s67, v167
    v_cvt_pk_bf16_f32 v99, v168, v169
    v_cvt_pk_bf16_f32 v103, v170, v171
    s_waitcnt lgkmcnt(9)
    v_dot2_f32_bf16 v168, v146, s67, 0
    v_dot2_f32_bf16 v169, v148, s67, 0
    v_dot2_f32_bf16 v170, v154, s67, 0
    v_dot2_f32_bf16 v171, v156, s67, 0
    v_dot2_f32_bf16 v168, v150, s66, v168
    v_dot2_f32_bf16 v169, v152, s66, v169
    v_dot2_f32_bf16 v170, v155, s66, v170
    v_dot2_f32_bf16 v171, v157, s66, v171
    v_cvt_pk_bf16_f32 v104, v164, v165
    v_cvt_pk_bf16_f32 v108, v166, v167
    s_setprio 1
    s_waitcnt lgkmcnt(5)
    v_dot2_f32_bf16 v164, v154, s66, 0
    v_dot2_f32_bf16 v165, v156, s66, 0
    v_dot2_f32_bf16 v166, v160, s67, 0
    v_dot2_f32_bf16 v167, v161, s67, 0
    v_dot2_f32_bf16 v164, v158, s66, v164
    v_dot2_f32_bf16 v165, v159, s66, v165
    v_dot2_f32_bf16 v166, v155, s67, v166
    v_dot2_f32_bf16 v167, v157, s67, v167
    v_cvt_pk_bf16_f32 v105, v168, v169
    v_cvt_pk_bf16_f32 v109, v170, v171
    s_add_u32 m0, s100, 2048
    v_lshl_add_u32 v58, v58, 6, v252
    buffer_load_dwordx4 v58, s[36:39], 0 offen lds
    s_waitcnt lgkmcnt(5)
    v_dot2_f32_bf16 v168, v160, s66, 0
    v_dot2_f32_bf16 v169, v161, s66, 0
    v_dot2_f32_bf16 v170, v151, s66, 0
    v_dot2_f32_bf16 v171, v153, s66, 0
    v_dot2_f32_bf16 v168, v158, s67, v168
    v_dot2_f32_bf16 v169, v159, s67, v169
    v_dot2_f32_bf16 v170, v147, s67, v170
    v_dot2_f32_bf16 v171, v149, s67, v171
    v_cvt_pk_bf16_f32 v106, v164, v165
    v_cvt_pk_bf16_f32 v110, v166, v167
    s_waitcnt lgkmcnt(2)
    v_lshlrev_b32 v164, 16, v128
    v_and_b32 v165, 0xffff0000, v129
    v_and_b32 v166, 0xffff0000, v128
    v_lshlrev_b32 v167, 16, v130
    v_cvt_pk_bf16_f32 v107, v168, v169
    v_cvt_pk_bf16_f32 v111, v170, v171
    s_setprio 0
    s_waitcnt lgkmcnt(1)
    v_lshlrev_b32 v168, 16, v131
    v_and_b32 v169, 0xffff0000, v130
    v_and_b32 v170, 0xffff0000, v131
    v_lshlrev_b32 v171, 16, v129
    v_cvt_pk_bf16_f32 v112, v164, v165
    v_cvt_pk_bf16_f32 v116, v166, v167
    s_waitcnt lgkmcnt(0)
    v_lshlrev_b32 v164, 16, v132
    v_and_b32 v166, 0xffff0000, v132
    v_cvt_pk_bf16_f32 v113, v168, v169
    v_cvt_pk_bf16_f32 v117, v170, v171
    v_cvt_pk_bf16_f32 v114, v164, v21
    v_cvt_pk_bf16_f32 v118, v166, 0
    s_nop 2
    v_cvt_pk_bf16_f32 v115, 0, 0
    v_cvt_pk_bf16_f32 v119, 0, 0
    ds_write_b128 v52, v[96:99] offset:320
    ds_write_b128 v52, v[100:103] offset:336
    ds_write_b128 v52, v[104:107] offset:448
    ds_write_b128 v52, v[108:111] offset:464
    s_mov_b32 exec_lo, 0xffff0000
    s_mov_b32 exec_hi, 0xffff0000
    ds_write_b128 v52, v[112:115] offset:1408
    ds_write_b128 v52, v[116:119] offset:1424
    s_mov_b64 exec, -1
    s_waitcnt vmcnt(2)
    s_branch L_folded
L_fold6:
    ds_read_b32 v128, v50 offset:632
    ds_read_b32 v129, v50 offset:232
    ds_read_b32 v130, v50 offset:740
    ds_read_b32 v131, v50 offset:340
    ds_read_b32 v132, v50 offset:684
    ds_read_b32 v133, v50 offset:284
    ds_read_b32 v134, v50 offset:392
    ds_read_b32 v135, v50 offset:792
    ds_read_b32 v136, v50 offset:288
    ds_read_b32 v137, v50 offset:736
    ds_read_b32 v138, v50 offset:636
    ds_read_b32 v139, v50 offset:388
    ds_read_b32 v140, v50 offset:236
    ds_read_b32 v141, v50 offset:336
    ds_read_b32 v142, v50 offset:788
    ds_read_b32 v143, v50 offset:688
    s_setprio 3
    ds_read_b32 v146, v50 offset:848
    ds_read_b32 v147, v50 offset:448
    ds_read_b32 v148, v50 offset:956
    ds_read_b32 v149, v50 offset:556
    ds_read_b32 v150, v50 offset:500
    s_waitcnt lgkmcnt(13)
    v_dot2_f32_bf16 v164, v128, s66, 0
    v_dot2_f32_bf16 v165, v130, s66, 0
    v_dot2_f32_bf16 v166, v132, s67, 0
    v_dot2_f32_bf16 v167, v134, s67, 0
    v_dot2_f32_bf16 v164, v129, s66, v164
    v_dot2_f32_bf16 v165, v131, s66, v165
    v_dot2_f32_bf16 v166, v133, s67, v166
    v_dot2_f32_bf16 v167, v135, s67, v167
    s_add_u32 m0, s100, 1024
    v_lshl_add_u32 v57, v57, 6, v252
    buffer_load_dwordx4 v57, s[36:39], 0 offen lds
    ds_read_b32 v151, v50 offset:900
    ds_read_b32 v152, v50 offset:608
    ds_read_b32 v153, v50 offset:1008
    ds_read_b32 v154, v50 offset:952
    ds_read_b32 v155, v50 offset:504
    s_waitcnt lgkmcnt(14)
    v_dot2_f32_bf16 v168, v132, s66, 0
    v_dot2_f32_bf16 v169, v135, s66, 0
    v_dot2_f32_bf16 v170, v136, s66, 0
    v_dot2_f32_bf16 v171, v138, s67, 0
    v_dot2_f32_bf16 v168, v129, s67, v168
    v_dot2_f32_bf16 v169, v131, s67, v169
    v_dot2_f32_bf16 v170, v137, s67, v170
    v_dot2_f32_bf16 v171, v139, s66, v171
    v_cvt_pk_bf16_f32 v96, v164, v165
    v_cvt_pk_bf16_f32 v100, v166, v167
    ds_read_b32 v156, v50 offset:852
    ds_read_b32 v157, v50 offset:604
    ds_read_b32 v158, v50 offset:452
    ds_read_b32 v159, v50 offset:552
    ds_read_b32 v160, v50 offset:1004
    s_waitcnt lgkmcnt(15)
    v_dot2_f32_bf16 v164, v137, s66, 0
    v_dot2_f32_bf16 v165, v141, s66, 0
    v_dot2_f32_bf16 v166, v136, s67, 0
    v_dot2_f32_bf16 v167, v139, s67, 0
    v_dot2_f32_bf16 v164, v140, s66, v164
    v_dot2_f32_bf16 v165, v138, s66, v165
    v_dot2_f32_bf16 v166, v142, s67, v166
    v_dot2_f32_bf16 v167, v143, s67, v167
    v_cvt_pk_bf16_f32 v97, v168, v169
    v_cvt_pk_bf16_f32 v101, v170, v171
    s_setprio 2
    ds_read_b32 v161, v50 offset:904
    s_waitcnt lgkmcnt(15)
    v_dot2_f32_bf16 v168, v140, s67, 0
    v_dot2_f32_bf16 v169, v141, s67, 0
    v_dot2_f32_bf16 v170, v128, s67, 0
    v_dot2_f32_bf16 v171, v130, s67, 0
    v_dot2_f32_bf16 v168, v142, s66, v168
    v_dot2_f32_bf16 v169, v143, s66, v169
    v_dot2_f32_bf16 v170, v133, s66, v170
    v_dot2_f32_bf16 v171, v134, s66, v171
    v_cvt_pk_bf16_f32 v98, v164, v165
    v_cvt_pk_bf16_f32 v102, v166, v167
    ds_read_b32 v128, v51 offset:8
    ds_read_b32 v129, v51 offset:16
    ds_read_b32 v130, v51 offset:20
    ds_read_b32 v131, v51 offset:12
    ds_read_b32 v132, v51 offset:24
    s_waitcnt lgkmcnt(13)
    v_dot2_f32_bf16 v164, v146, s66, 0
    v_dot2_f32_bf16 v165, v148, s66, 0
    v_dot2_f32_bf16 v166, v150, s67, 0
    v_dot2_f32_bf16 v167, v152, s67, 0
    v_dot2_f32_bf16 v164, v147, s66, v164
    v_dot2_f32_bf16 v165, v149, s66, v165
    v_dot2_f32_bf16 v166, v151, s67, v166
    v_dot2_f32_bf16 v167, v153, s67, v167
    v_cvt_pk_bf16_f32 v99, v168, v169
    v_cvt_pk_bf16_f32 v103, v170, v171
    ds_read_b32 v133, v51 offset:32
    ds_read_b32 v134, v51 offset:36
    ds_read_b32 v135, v51 offset:28
    s_waitcnt lgkmcnt(12)
    v_dot2_f32_bf16 v168, v151, s66, 0
    v_dot2_f32_bf16 v169, v153, s66, 0
    v_dot2_f32_bf16 v170, v154, s67, 0
    v_dot2_f32_bf16 v171, v156, s67, 0
    v_dot2_f32_bf16 v168, v147, s67, v168
    v_dot2_f32_bf16 v169, v149, s67, v169
    v_dot2_f32_bf16 v170, v155, s66, v170
    v_dot2_f32_bf16 v171, v157, s66, v171
    v_cvt_pk_bf16_f32 v104, v164, v165
    v_cvt_pk_bf16_f32 v108, v166, v167
    s_setprio 1
    s_waitcnt lgkmcnt(8)
    v_dot2_f32_bf16 v164, v158, s66, 0
    v_dot2_f32_bf16 v165, v159, s66, 0
    v_dot2_f32_bf16 v166, v160, s67, 0
    v_dot2_f32_bf16 v167, v161, s67, 0
    v_dot2_f32_bf16 v164, v154, s66, v164
    v_dot2_f32_bf16 v165, v156, s66, v165
    v_dot2_f32_bf16 v166, v155, s67, v166
    v_dot2_f32_bf16 v167, v157, s67, v167
    v_cvt_pk_bf16_f32 v105, v168, v169
    v_cvt_pk_bf16_f32 v109, v170, v171
    s_add_u32 m0, s100, 2048
    v_lshl_add_u32 v58, v58, 6, v252
    buffer_load_dwordx4 v58, s[36:39], 0 offen lds
    s_waitcnt lgkmcnt(8)
    v_dot2_f32_bf16 v168, v160, s66, 0
    v_dot2_f32_bf16 v169, v159, s67, 0
    v_dot2_f32_bf16 v170, v150, s66, 0
    v_dot2_f32_bf16 v171, v152, s66, 0
    v_dot2_f32_bf16 v168, v158, s67, v168
    v_dot2_f32_bf16 v169, v161, s66, v169
    v_dot2_f32_bf16 v170, v146, s67, v170
    v_dot2_f32_bf16 v171, v148, s67, v171
    v_cvt_pk_bf16_f32 v106, v164, v165
    v_cvt_pk_bf16_f32 v110, v166, v167
    s_waitcnt lgkmcnt(5)
    v_lshlrev_b32 v164, 16, v128
    v_and_b32 v165, 0xffff0000, v129
    v_and_b32 v166, 0xffff0000, v128
    v_lshlrev_b32 v167, 16, v130
    v_cvt_pk_bf16_f32 v107, v168, v169
    v_cvt_pk_bf16_f32 v111, v170, v171
    s_setprio 0
    s_waitcnt lgkmcnt(4)
    v_lshlrev_b32 v168, 16, v131
    v_and_b32 v169, 0xffff0000, v130
    v_and_b32 v170, 0xffff0000, v131
    v_lshlrev_b32 v171, 16, v129
    v_cvt_pk_bf16_f32 v112, v164, v165
    v_cvt_pk_bf16_f32 v116, v166, v167
    s_waitcnt lgkmcnt(1)
    v_lshlrev_b32 v164, 16, v132
    v_and_b32 v165, 0xffff0000, v133
    v_and_b32 v166, 0xffff0000, v132
    v_lshlrev_b32 v167, 16, v134
    v_cvt_pk_bf16_f32 v113, v168, v169
    v_cvt_pk_bf16_f32 v117, v170, v171
    s_waitcnt lgkmcnt(0)
    v_lshlrev_b32 v168, 16, v135
    v_and_b32 v169, 0xffff0000, v134
    v_and_b32 v170, 0xffff0000, v135
    v_lshlrev_b32 v171, 16, v133
    v_cvt_pk_bf16_f32 v114, v164, v165
    v_cvt_pk_bf16_f32 v118, v166, v167
    s_nop 2
    v_cvt_pk_bf16_f32 v115, v168, v169
    v_cvt_pk_bf16_f32 v119, v170, v171
    ds_write_b128 v52, v[96:99] offset:256
    ds_write_b128 v52, v[100:103] offset:272
    ds_write_b128 v52, v[104:107] offset:512
    ds_write_b128 v52, v[108:111] offset:528
    s_mov_b32 exec_lo, 0xffff0000
    s_mov_b32 exec_hi, 0xffff0000
    ds_write_b128 v52, v[112:115] offset:1376
    ds_write_b128 v52, v[116:119] offset:1392
    s_mov_b64 exec, -1
    s_waitcnt vmcnt(2)
    s_branch L_folded
L_fold0:
    ds_read_b32 v128, v50 offset:752
    ds_read_b32 v129, v50 offset:652
    ds_read_b32 v130, v50 offset:628
    ds_read_b32 v131, v50 offset:128
    ds_read_b32 v132, v50 offset:704
    ds_read_b32 v133, v50 offset:804
    ds_read_b32 v134, v50 offset:680
    ds_read_b32 v135, v50 offset:180
    ds_read_b32 v136, v50 offset:132
    ds_read_b32 v137, v50 offset:732
    ds_read_b32 v138, v50 offset:184
    ds_read_b32 v139, v50 offset:784
    ds_read_b32 v140, v50 offset:864
    ds_read_b32 v141, v50 offset:916
    ds_read_b32 v142, v50 offset:972
    ds_read_b32 v143, v50 offset:1024
    ds_read_b32 v144, v50 offset:920
    ds_read_b32 v145, v50 offset:968
    s_setprio 3
    ds_read_b32 v146, v50 offset:0
    ds_read_b32 v147, v50 offset:1296
    ds_read_b32 v148, v50 offset:1348
    ds_read_b32 v149, v50 offset:52
    ds_read_b32 v150, v50 offset:1300
    s_waitcnt lgkmcnt(15)
    v_dot2_f32_bf16 v164, v128, s66, 0
    v_dot2_f32_bf16 v165, v130, s66, 0
    v_dot2_f32_bf16 v166, v132, s67, 0
    v_dot2_f32_bf16 v167, v134, s67, 0
    v_dot2_f32_bf16 v164, v129, s66, v164
    v_dot2_f32_bf16 v165, v131, s66, v165
    v_dot2_f32_bf16 v166, v133, s67, v166
    v_dot2_f32_bf16 v167, v135, s67, v167
    s_add_u32 m0, s100, 1024
    v_lshl_add_u32 v57, v57, 6, v252
    buffer_load_dwordx4 v57, s[36:39], 0 offen lds
    buffer_load_dword v255, v251, s[40:43], s69 offen
    ds_read_b32 v151, v50 offset:48
    ds_read_b32 v152, v50 offset:1248
    ds_read_b32 v153, v50 offset:100
    ds_read_b32 v154, v50 offset:1252
    ds_read_b32 v155, v50 offset:152
    s_waitcnt lgkmcnt(15)
    v_dot2_f32_bf16 v168, v136, s66, 0
    v_dot2_f32_bf16 v169, v135, s66, 0
    v_dot2_f32_bf16 v170, v138, s67, 0
    v_dot2_f32_bf16 v171, v134, s66, 0
    v_dot2_f32_bf16 v168, v137, s66, v168
    v_dot2_f32_bf16 v169, v130, s67, v169
    v_dot2_f32_bf16 v170, v139, s67, v170
    v_dot2_f32_bf16 v171, v131, s67, v171
    v_cvt_pk_bf16_f32 v96, v164, v165
    v_cvt_pk_bf16_f32 v100, v166, v167
    ds_read_b32 v156, v50 offset:4
    ds_read_b32 v157, v50 offset:104
    ds_read_b32 v158, v50 offset:204
    ds_read_b32 v159, v50 offset:1304
    ds_read_b32 v160, v50 offset:156
    s_waitcnt lgkmcnt(15)
    v_dot2_f32_bf16 v164, v137, s67, 0
    v_lshlrev_b32 v165, 16, v140
    v_dot2_f32_bf16 v166, v136, s67, 0
    v_and_b32 v167, 0xffff0000, v141
    v_dot2_f32_bf16 v164, v138, s66, v164
    v_dot2_f32_bf16 v166, v139, s66, v166
    v_cvt_pk_bf16_f32 v97, v168, v169
    v_cvt_pk_bf16_f32 v101, v170, v171
    s_setprio 2
    ds_read_b32 v161, v50 offset:56
    s_waitcnt lgkmcnt(15)
    v_lshlrev_b32 v168, 16, v142
    v_dot2_f32_bf16 v169, v141, s66, 0
    v_and_b32 v170, 0xffff0000, v143
    v_dot2_f32_bf16 v171, v144, s66, 0
    v_dot2_f32_bf16 v169, v140, s67, v169
    v_dot2_f32_bf16 v171, v145, s67, v171
    v_cvt_pk_bf16_f32 v98, v164, v165
    v_cvt_pk_bf16_f32 v102, v166, v167
    ds_read_b32 v128, v50 offset:1256
    ds_read_b32 v129, v50 offset:256
    ds_read_b32 v130, v50 offset:12
    ds_read_b32 v131, v50 offset:312
    ds_read_b32 v132, v50 offset:308
    s_waitcnt lgkmcnt(15)
    v_lshlrev_b32 v164, 16, v146
    v_dot2_f32_bf16 v165, v147, s67, 0
    v_and_b32 v166, 0xffff0000, v149
    v_dot2_f32_bf16 v167, v150, s66, 0
    v_dot2_f32_bf16 v165, v148, s66, v165
    v_dot2_f32_bf16 v167, v151, s67, v167
    v_cvt_pk_bf16_f32 v99, v168, v169
    v_cvt_pk_bf16_f32 v103, v170, v171
    ds_read_b32 v133, v50 offset:1308
    ds_read_b32 v134, v50 offset:64
    ds_read_b32 v135, v50 offset:364
    ds_read_b32 v136, v50 offset:260
    ds_read_b32 v137, v50 offset:8
    s_waitcnt lgkmcnt(15)
    v_dot2_f32_bf16 v168, v146, s67, 0
    v_dot2_f32_bf16 v169, v151, s66, 0
    v_dot2_f32_bf16 v170, v153, s66, 0
    v_dot2_f32_bf16 v171, v150, s67, 0
    v_dot2_f32_bf16 v168, v149, s66, v168
    v_dot2_f32_bf16 v169, v152, s66, v169
    v_dot2_f32_bf16 v170, v152, s67, v170
    v_dot2_f32_bf16 v171, v153, s67, v171
    v_cvt_pk_bf16_f32 v104, v164, v165
    v_cvt_pk_bf16_f32 v108, v166, v167
    s_setprio 1
    ds_read_b32 v138, v50 offset:412
    ds_read_b32 v139, v50 offset:1260
    ds_read_b32 v140, v50 offset:208
    ds_read_b32 v141, v50 offset:360
    ds_read_b32 v142, v50 offset:60
    s_waitcnt lgkmcnt(15)
    v_dot2_f32_bf16 v164, v154, s66, 0
    v_dot2_f32_bf16 v165, v156, s66, 0
    v_dot2_f32_bf16 v166, v158, s67, 0
    v_dot2_f32_bf16 v167, v160, s67, 0
    v_dot2_f32_bf16 v164, v155, s66, v164
    v_dot2_f32_bf16 v165, v157, s66, v165
    v_dot2_f32_bf16 v166, v159, s67, v166
    v_dot2_f32_bf16 v167, v161, s67, v167
    v_cvt_pk_bf16_f32 v105, v168, v169
    v_cvt_pk_bf16_f32 v109, v170, v171
    s_add_u32 m0, s100, 2048
    v_lshl_add_u32 v58, v58, 6, v252
    buffer_load_dwordx4 v58, s[36:39], 0 offen lds
    ds_read_b32 v143, v50 offset:1312
    s_waitcnt lgkmcnt(15)
    v_dot2_f32_bf16 v168, v158, s66, 0
    v_dot2_f32_bf16 v169, v156, s67, 0
    v_dot2_f32_bf16 v170, v159, s66, 0
    v_dot2_f32_bf16 v171, v161, s66, 0
    v_dot2_f32_bf16 v168, v154, s67, v168
    v_dot2_f32_bf16 v169, v160, s66, v169
    v_dot2_f32_bf16 v170, v155, s67, v170
    v_dot2_f32_bf16 v171, v157, s67, v171
    v_cvt_pk_bf16_f32 v106, v164, v165
    v_cvt_pk_bf16_f32 v110, v166, v167
    s_waitcnt lgkmcnt(8)
    v_dot2_f32_bf16 v164, v128, s66, 0
    v_dot2_f32_bf16 v165, v130, s66, 0
    v_dot2_f32_bf16 v166, v132, s67, 0
    v_dot2_f32_bf16 v167, v134, s67, 0
    v_dot2_f32_bf16 v164, v129, s66, v164
    v_dot2_f32_bf16 v165, v131, s66, v165
    v_dot2_f32_bf16 v166, v133, s67, v166
    v_dot2_f32_bf16 v167, v135, s67, v167
    v_cvt_pk_bf16_f32 v107, v168, v169
    v_cvt_pk_bf16_f32 v111, v170, v171
    s_setprio 0
    s_waitcnt lgkmcnt(4)
    v_dot2_f32_bf16 v168, v133, s66, 0
    v_dot2_f32_bf16 v169, v131, s67, 0
    v_dot2_f32_bf16 v170, v136, s66, 0
    v_dot2_f32_bf16 v171, v138, s66, 0
    v_dot2_f32_bf16 v168, v129, s67, v168
    v_dot2_f32_bf16 v169, v134, s66, v169
    v_dot2_f32_bf16 v170, v137, s67, v170
    v_dot2_f32_bf16 v171, v139, s67, v171
    v_cvt_pk_bf16_f32 v112, v164, v165
    v_cvt_pk_bf16_f32 v116, v166, v167
    s_waitcnt lgkmcnt(0)
    v_dot2_f32_bf16 v164, v140, s66, 0
    v_dot2_f32_bf16 v165, v141, s66, 0
    v_dot2_f32_bf16 v166, v136, s67, 0
    v_dot2_f32_bf16 v167, v143, s67, 0
    v_dot2_f32_bf16 v164, v137, s66, v164
    v_dot2_f32_bf16 v165, v139, s66, v165
    v_dot2_f32_bf16 v166, v142, s67, v166
    v_dot2_f32_bf16 v167, v138, s67, v167
    v_cvt_pk_bf16_f32 v113, v168, v169
    v_cvt_pk_bf16_f32 v117, v170, v171
    s_waitcnt lgkmcnt(0)
    v_dot2_f32_bf16 v168, v140, s67, 0
    v_dot2_f32_bf16 v169, v143, s66, 0
    v_dot2_f32_bf16 v170, v128, s67, 0
    v_dot2_f32_bf16 v171, v130, s67, 0
    v_dot2_f32_bf16 v168, v142, s66, v168
    v_dot2_f32_bf16 v169, v141, s67, v169
    v_dot2_f32_bf16 v170, v132, s66, v170
    v_dot2_f32_bf16 v171, v135, s66, v171
    v_cvt_pk_bf16_f32 v114, v164, v165
    v_cvt_pk_bf16_f32 v118, v166, v167
    s_nop 2
    v_cvt_pk_bf16_f32 v115, v168, v169
    v_cvt_pk_bf16_f32 v119, v170, v171
    ds_write_b128 v52, v[96:99] offset:384
    ds_write_b128 v52, v[100:103] offset:400
    ds_write_b128 v52, v[104:107] offset:1024
    ds_write_b128 v52, v[108:111] offset:1040
    ds_write_b128 v52, v[112:115] offset:1088
    ds_write_b128 v52, v[116:119] offset:1104
    s_waitcnt vmcnt(3)
    s_branch L_folded
L_fold1:
    ds_read_b32 v128, v50 offset:1024
    ds_read_b32 v129, v50 offset:972
    ds_read_b32 v130, v50 offset:968
    ds_read_b32 v131, v50 offset:868
    ds_read_b32 v132, v50 offset:1020
    ds_read_b32 v133, v50 offset:920
    ds_read_b32 v134, v50 offset:836
    ds_read_b32 v135, v50 offset:136
    ds_read_b32 v136, v50 offset:140
    ds_read_b32 v137, v50 offset:940
    ds_read_b32 v138, v50 offset:888
    ds_read_b32 v139, v50 offset:188
    ds_read_b32 v140, v50 offset:992
    ds_read_b32 v141, v50 offset:192
    ds_read_b32 v142, v50 offset:1080
    ds_read_b32 v143, v50 offset:1188
    ds_read_b32 v144, v50 offset:1132
    ds_read_b32 v145, v50 offset:1240
    s_setprio 3
    ds_read_b32 v146, v50 offset:1072
    ds_read_b32 v147, v50 offset:872
    ds_read_b32 v148, v50 offset:1180
    ds_read_b32 v149, v50 offset:980
    ds_read_b32 v150, v50 offset:1124
    s_waitcnt lgkmcnt(15)
    v_dot2_f32_bf16 v164, v128, s66, 0
    v_dot2_f32_bf16 v165, v130, s66, 0
    v_dot2_f32_bf16 v166, v131, s67, 0
    v_dot2_f32_bf16 v167, v133, s67, 0
    v_dot2_f32_bf16 v164, v129, s67, v164
    v_dot2_f32_bf16 v165, v131, s66, v165
    v_dot2_f32_bf16 v166, v132, s66, v166
    v_dot2_f32_bf16 v167, v132, s67, v167
    s_add_u32 m0, s100, 1024
    v_lshl_add_u32 v57, v57, 6, v252
    buffer_load_dwordx4 v57, s[36:39], 0 offen lds
    ds_read_b32 v151, v50 offset:924
    ds_read_b32 v152, v50 offset:1232
    ds_read_b32 v153, v50 offset:1032
    ds_read_b32 v154, v50 offset:928
    ds_read_b32 v155, v50 offset:1176
    s_waitcnt lgkmcnt(14)
    v_dot2_f32_bf16 v168, v134, s66, 0
    v_dot2_f32_bf16 v169, v136, s66, 0
    v_dot2_f32_bf16 v170, v138, s67, 0
    v_dot2_f32_bf16 v171, v140, s67, 0
    v_dot2_f32_bf16 v168, v135, s66, v168
    v_dot2_f32_bf16 v169, v137, s66, v169
    v_dot2_f32_bf16 v170, v139, s67, v170
    v_dot2_f32_bf16 v171, v141, s67, v171
    v_cvt_pk_bf16_f32 v96, v164, v165
    v_cvt_pk_bf16_f32 v100, v166, v167
    ds_read_b32 v156, v50 offset:1028
    ds_read_b32 v157, v50 offset:1076
    ds_read_b32 v158, v50 offset:876
    ds_read_b32 v159, v50 offset:976
    ds_read_b32 v160, v50 offset:1228
    s_waitcnt lgkmcnt(15)
    v_dot2_f32_bf16 v164, v134, s67, 0
    v_dot2_f32_bf16 v165, v141, s66, 0
    v_dot2_f32_bf16 v166, v138, s66, 0
    v_dot2_f32_bf16 v167, v140, s66, 0
    v_dot2_f32_bf16 v164, v139, s66, v164
    v_dot2_f32_bf16 v165, v137, s67, v165
    v_dot2_f32_bf16 v166, v135, s67, v166
    v_dot2_f32_bf16 v167, v136, s67, v167
    v_cvt_pk_bf16_f32 v97, v168, v169
    v_cvt_pk_bf16_f32 v101, v170, v171
    s_setprio 2
    ds_read_b32 v161, v50 offset:1128
    s_waitcnt lgkmcnt(15)
    v_lshlrev_b32 v168, 16, v142
    v_lshlrev_b32 v169, 16, v143
    v_and_b32 v170, 0xffff0000, v144
    v_and_b32 v171, 0xffff0000, v145
    v_cvt_pk_bf16_f32 v98, v164, v165
    v_cvt_pk_bf16_f32 v102, v166, v167
    ds_read_b32 v128, v50 offset:464
    ds_read_b32 v129, v50 offset:1264
    ds_read_b32 v130, v50 offset:520
    ds_read_b32 v131, v50 offset:20
    ds_read_b32 v132, v50 offset:516
    s_waitcnt lgkmcnt(13)
    v_dot2_f32_bf16 v164, v146, s66, 0
    v_dot2_f32_bf16 v165, v148, s66, 0
    v_dot2_f32_bf16 v166, v150, s67, 0
    v_dot2_f32_bf16 v167, v152, s67, 0
    v_dot2_f32_bf16 v164, v147, s66, v164
    v_dot2_f32_bf16 v165, v149, s66, v165
    v_dot2_f32_bf16 v166, v151, s67, v166
    v_dot2_f32_bf16 v167, v153, s67, v167
    v_cvt_pk_bf16_f32 v99, v168, v169
    v_cvt_pk_bf16_f32 v103, v170, v171
    buffer_load_dword v255, v251, s[40:43], s69 offen
    ds_read_b32 v133, v50 offset:1316
    ds_read_b32 v134, v50 offset:572
    ds_read_b32 v135, v50 offset:72
    ds_read_b32 v136, v50 offset:468
    ds_read_b32 v137, v50 offset:16
    s_waitcnt lgkmcnt(14)
    v_dot2_f32_bf16 v168, v147, s67, 0
    v_dot2_f32_bf16 v169, v152, s66, 0
    v_dot2_f32_bf16 v170, v154, s66, 0
    v_dot2_f32_bf16 v171, v156, s66, 0
    v_dot2_f32_bf16 v168, v150, s66, v168
    v_dot2_f32_bf16 v169, v149, s67, v169
    v_dot2_f32_bf16 v170, v155, s67, v170
    v_dot2_f32_bf16 v171, v157, s67, v171
    v_cvt_pk_bf16_f32 v104, v164, v165
    v_cvt_pk_bf16_f32 v108, v166, v167
    s_setprio 1
    ds_read_b32 v138, v50 offset:620
    ds_read_b32 v139, v50 offset:1268
    ds_read_b32 v140, v50 offset:416
    ds_read_b32 v141, v50 offset:568
    ds_read_b32 v142, v50 offset:68
    s_waitcnt lgkmcnt(15)
    v_dot2_f32_bf16 v164, v158, s66, 0
    v_dot2_f32_bf16 v165, v157, s66, 0
    v_dot2_f32_bf16 v166, v160, s67, 0
    v_dot2_f32_bf16 v167, v161, s67, 0
    v_dot2_f32_bf16 v164, v155, s66, v164
    v_dot2_f32_bf16 v165, v159, s66, v165
    v_dot2_f32_bf16 v166, v154, s67, v166
    v_dot2_f32_bf16 v167, v156, s67, v167
    v_cvt_pk_bf16_f32 v105, v168, v169
    v_cvt_pk_bf16_f32 v109, v170, v171
    s_add_u32 m0, s100, 2048
    v_lshl_add_u32 v58, v58, 6, v252
    buffer_load_dwordx4 v58, s[36:39], 0 offen lds
    ds_read_b32 v143, v50 offset:1320
    s_waitcnt lgkmcnt(15)
    v_dot2_f32_bf16 v168, v160, s66, 0
    v_dot2_f32_bf16 v169, v159, s67, 0
    v_dot2_f32_bf16 v170, v146, s67, 0
    v_dot2_f32_bf16 v171, v148, s67, 0
    v_dot2_f32_bf16 v168, v158, s67, v168
    v_dot2_f32_bf16 v169, v161, s66, v169
    v_dot2_f32_bf16 v170, v151, s66, v170
    v_dot2_f32_bf16 v171, v153, s66, v171
    v_cvt_pk_bf16_f32 v106, v164, v165
    v_cvt_pk_bf16_f32 v110, v166, v167
    s_waitcnt lgkmcnt(8)
    v_dot2_f32_bf16 v164, v128, s66, 0
    v_dot2_f32_bf16 v165, v130, s66, 0
    v_dot2_f32_bf16 v166, v132, s67, 0
    v_dot2_f32_bf16 v167, v134, s67, 0
    v_dot2_f32_bf16 v164, v129, s66, v164
    v_dot2_f32_bf16 v165, v131, s66, v165
    v_dot2_f32_bf16 v166, v133, s67, v166
    v_dot2_f32_bf16 v167, v135, s67, v167
    v_cvt_pk_bf16_f32 v107, v168, v169
    v_cvt_pk_bf16_f32 v111, v170, v171
    s_setprio 0
    s_waitcnt lgkmcnt(4)
    v_dot2_f32_bf16 v168, v128, s67, 0
    v_dot2_f32_bf16 v169, v130, s67, 0
    v_dot2_f32_bf16 v170, v136, s66, 0
    v_dot2_f32_bf16 v171, v138, s66, 0
    v_dot2_f32_bf16 v168, v133, s66, v168
    v_dot2_f32_bf16 v169, v135, s66, v169
    v_dot2_f32_bf16 v170, v137, s67, v170
    v_dot2_f32_bf16 v171, v139, s67, v171
    v_cvt_pk_bf16_f32 v112, v164, v165
    v_cvt_pk_bf16_f32 v116, v166, v167
    s_waitcnt lgkmcnt(0)
    v_dot2_f32_bf16 v164, v137, s66, 0
    v_dot2_f32_bf16 v165, v139, s66, 0
    v_dot2_f32_bf16 v166, v136, s67, 0
    v_dot2_f32_bf16 v167, v143, s67, 0
    v_dot2_f32_bf16 v164, v140, s66, v164
    v_dot2_f32_bf16 v165, v141, s66, v165
    v_dot2_f32_bf16 v166, v142, s67, v166
    v_dot2_f32_bf16 v167, v138, s67, v167
    v_cvt_pk_bf16_f32 v113, v168, v169
    v_cvt_pk_bf16_f32 v117, v170, v171
    s_waitcnt lgkmcnt(0)
    v_dot2_f32_bf16 v168, v142, s66, 0
    v_dot2_f32_bf16 v169, v143, s66, 0
    v_dot2_f32_bf16 v170, v129, s67, 0
    v_dot2_f32_bf16 v171, v131, s67, 0
    v_dot2_f32_bf16 v168, v140, s67, v168
    v_dot2_f32_bf16 v169, v141, s67, v169
    v_dot2_f32_bf16 v170, v132, s66, v170
    v_dot2_f32_bf16 v171, v134, s66, v171
    v_cvt_pk_bf16_f32 v114, v164, v165
    v_cvt_pk_bf16_f32 v118, v166, v167
    s_nop 2
    v_cvt_pk_bf16_f32 v115, v168, v169
    v_cvt_pk_bf16_f32 v119, v170, v171
    ds_write_b128 v52, v[96:99] offset:640
    ds_write_b128 v52, v[100:103] offset:656
    ds_write_b128 v52, v[104:107] offset:896
    ds_write_b128 v52, v[108:111] offset:912
    ds_write_b128 v52, v[112:115] offset:1152
    ds_write_b128 v52, v[116:119] offset:1168
    s_waitcnt vmcnt(3)
    s_branch L_folded
L_fold2:
    ds_read_b32 v128, v50 offset:1132
    ds_read_b32 v129, v50 offset:1080
    ds_read_b32 v130, v50 offset:1240
    ds_read_b32 v131, v50 offset:1188
    ds_read_b32 v132, v50 offset:1184
    ds_read_b32 v133, v50 offset:1136
    ds_read_b32 v134, v50 offset:1084
    ds_read_b32 v135, v50 offset:1236
    ds_read_b32 v136, v50 offset:144
    ds_read_b32 v137, v50 offset:1044
    ds_read_b32 v138, v50 offset:1096
    ds_read_b32 v139, v50 offset:196
    ds_read_b32 v140, v50 offset:1148
    ds_read_b32 v141, v50 offset:148
    ds_read_b32 v142, v50 offset:200
    ds_read_b32 v143, v50 offset:1200
    ds_read_b32 v144, v50 offset:1296
    ds_read_b32 v145, v50 offset:1348
    s_setprio 3
    ds_read_b32 v146, v50 offset:1064
    ds_read_b32 v147, v50 offset:664
    ds_read_b32 v148, v50 offset:1172
    ds_read_b32 v149, v50 offset:772
    ds_read_b32 v150, v50 offset:716
    s_waitcnt lgkmcnt(15)
    v_dot2_f32_bf16 v164, v128, s66, 0
    v_dot2_f32_bf16 v165, v130, s66, 0
    v_dot2_f32_bf16 v166, v132, s67, 0
    v_dot2_f32_bf16 v167, v134, s67, 0
    v_dot2_f32_bf16 v164, v129, s67, v164
    v_dot2_f32_bf16 v165, v131, s67, v165
    v_dot2_f32_bf16 v166, v133, s66, v166
    v_dot2_f32_bf16 v167, v135, s66, v167
    s_add_u32 m0, s100, 1024
    v_lshl_add_u32 v57, v57, 6, v252
    buffer_load_dwordx4 v57, s[36:39], 0 offen lds
    ds_read_b32 v151, v50 offset:1116
    ds_read_b32 v152, v50 offset:824
    ds_read_b32 v153, v50 offset:1224
    ds_read_b32 v154, v50 offset:1168
    ds_read_b32 v155, v50 offset:720
    s_waitcnt lgkmcnt(15)
    v_dot2_f32_bf16 v168, v134, s66, 0
    v_dot2_f32_bf16 v169, v136, s66, 0
    v_dot2_f32_bf16 v170, v135, s67, 0
    v_dot2_f32_bf16 v171, v138, s67, 0
    v_dot2_f32_bf16 v168, v132, s66, v168
    v_dot2_f32_bf16 v169, v137, s66, v169
    v_dot2_f32_bf16 v170, v133, s67, v170
    v_dot2_f32_bf16 v171, v139, s67, v171
    v_cvt_pk_bf16_f32 v96, v164, v165
    v_cvt_pk_bf16_f32 v100, v166, v167
    ds_read_b32 v156, v50 offset:1068
    ds_read_b32 v157, v50 offset:820
    ds_read_b32 v158, v50 offset:668
    ds_read_b32 v159, v50 offset:768
    ds_read_b32 v160, v50 offset:1220
    s_waitcnt lgkmcnt(15)
    v_dot2_f32_bf16 v164, v140, s66, 0
    v_dot2_f32_bf16 v165, v139, s66, 0
    v_dot2_f32_bf16 v166, v142, s67, 0
    v_dot2_f32_bf16 v167, v138, s66, 0
    v_dot2_f32_bf16 v164, v141, s66, v164
    v_dot2_f32_bf16 v165, v137, s67, v165
    v_dot2_f32_bf16 v166, v143, s67, v166
    v_dot2_f32_bf16 v167, v136, s67, v167
    v_cvt_pk_bf16_f32 v97, v168, v169
    v_cvt_pk_bf16_f32 v101, v170, v171
    s_setprio 2
    ds_read_b32 v161, v50 offset:1120
    s_waitcnt lgkmcnt(15)
    v_dot2_f32_bf16 v168, v140, s67, 0
    v_lshlrev_b32 v169, 16, v144
    v_dot2_f32_bf16 v170, v143, s66, 0
    v_and_b32 v171, 0xffff0000, v145
    v_dot2_f32_bf16 v168, v142, s66, v168
    v_dot2_f32_bf16 v170, v141, s67, v170
    v_cvt_pk_bf16_f32 v98, v164, v165
    v_cvt_pk_bf16_f32 v102, v166, v167
    ds_read_b32 v128, v50 offset:672
    ds_read_b32 v129, v50 offset:1272
    ds_read_b32 v130, v50 offset:28
    ds_read_b32 v131, v50 offset:728
    ds_read_b32 v132, v50 offset:724
    s_waitcnt lgkmcnt(13)
    v_dot2_f32_bf16 v164, v146, s66, 0
    v_dot2_f32_bf16 v165, v148, s66, 0
    v_dot2_f32_bf16 v166, v150, s67, 0
    v_dot2_f32_bf16 v167, v152, s67, 0
    v_dot2_f32_bf16 v164, v147, s66, v164
    v_dot2_f32_bf16 v165, v149, s66, v165
    v_dot2_f32_bf16 v166, v151, s67, v166
    v_dot2_f32_bf16 v167, v153, s67, v167
    v_cvt_pk_bf16_f32 v99, v168, v169
    v_cvt_pk_bf16_f32 v103, v170, v171
    ds_read_b32 v133, v50 offset:1324
    ds_read_b32 v134, v50 offset:780
    ds_read_b32 v135, v50 offset:80
    ds_read_b32 v136, v50 offset:24
    ds_read_b32 v137, v50 offset:676
    s_waitcnt lgkmcnt(14)
    v_dot2_f32_bf16 v168, v147, s67, 0
    v_dot2_f32_bf16 v169, v149, s67, 0
    v_dot2_f32_bf16 v170, v154, s67, 0
    v_dot2_f32_bf16 v171, v156, s67, 0
    v_dot2_f32_bf16 v168, v151, s66, v168
    v_dot2_f32_bf16 v169, v153, s66, v169
    v_dot2_f32_bf16 v170, v155, s66, v170
    v_dot2_f32_bf16 v171, v157, s66, v171
    v_cvt_pk_bf16_f32 v104, v164, v165
    v_cvt_pk_bf16_f32 v108, v166, v167
    s_setprio 1
    ds_read_b32 v138, v50 offset:1276
    ds_read_b32 v139, v50 offset:828
    ds_read_b32 v140, v50 offset:624
    ds_read_b32 v141, v50 offset:776
    ds_read_b32 v142, v50 offset:76
    s_waitcnt lgkmcnt(15)
    v_dot2_f32_bf16 v164, v158, s66, 0
    v_dot2_f32_bf16 v165, v159, s66, 0
    v_dot2_f32_bf16 v166, v160, s67, 0
    v_dot2_f32_bf16 v167, v157, s67, 0
    v_dot2_f32_bf16 v164, v154, s66, v164
    v_dot2_f32_bf16 v165, v156, s66, v165
    v_dot2_f32_bf16 v166, v155, s67, v166
    v_dot2_f32_bf16 v167, v161, s67, v167
    v_cvt_pk_bf16_f32 v105, v168, v169
    v_cvt_pk_bf16_f32 v109, v170, v171
    s_add_u32 m0, s100, 2048
    v_lshl_add_u32 v58, v58, 6, v252
    buffer_load_dwordx4 v58, s[36:39], 0 offen lds
    ds_read_b32 v143, v50 offset:1328
    s_waitcnt lgkmcnt(15)
    v_dot2_f32_bf16 v168, v160, s66, 0
    v_dot2_f32_bf16 v169, v161, s66, 0
    v_dot2_f32_bf16 v170, v150, s66, 0
    v_dot2_f32_bf16 v171, v152, s66, 0
    v_dot2_f32_bf16 v168, v158, s67, v168
    v_dot2_f32_bf16 v169, v159, s67, v169
    v_dot2_f32_bf16 v170, v146, s67, v170
    v_dot2_f32_bf16 v171, v148, s67, v171
    v_cvt_pk_bf16_f32 v106, v164, v165
    v_cvt_pk_bf16_f32 v110, v166, v167
    s_waitcnt lgkmcnt(8)
    v_dot2_f32_bf16 v164, v128, s66, 0
    v_dot2_f32_bf16 v165, v130, s66, 0
    v_dot2_f32_bf16 v166, v132, s67, 0
    v_dot2_f32_bf16 v167, v134, s67, 0
    v_dot2_f32_bf16 v164, v129, s66, v164
    v_dot2_f32_bf16 v165, v131, s66, v165
    v_dot2_f32_bf16 v166, v133, s67, v166
    v_dot2_f32_bf16 v167, v135, s67, v167
    v_cvt_pk_bf16_f32 v107, v168, v169
    v_cvt_pk_bf16_f32 v111, v170, v171
    s_setprio 0
    s_waitcnt lgkmcnt(4)
    v_dot2_f32_bf16 v168, v133, s66, 0
    v_dot2_f32_bf16 v169, v131, s67, 0
    v_dot2_f32_bf16 v170, v136, s67, 0
    v_dot2_f32_bf16 v171, v138, s67, 0
    v_dot2_f32_bf16 v168, v128, s67, v168
    v_dot2_f32_bf16 v169, v135, s66, v169
    v_dot2_f32_bf16 v170, v137, s66, v170
    v_dot2_f32_bf16 v171, v139, s66, v171
    v_cvt_pk_bf16_f32 v112, v164, v165
    v_cvt_pk_bf16_f32 v116, v166, v167
    s_waitcnt lgkmcnt(0)
    v_dot2_f32_bf16 v164, v136, s66, 0
    v_dot2_f32_bf16 v165, v141, s66, 0
    v_dot2_f32_bf16 v166, v142, s67, 0
    v_dot2_f32_bf16 v167, v143, s67, 0
    v_dot2_f32_bf16 v164, v140, s66, v164
    v_dot2_f32_bf16 v165, v138, s66, v165
    v_dot2_f32_bf16 v166, v137, s67, v166
    v_dot2_f32_bf16 v167, v139, s67, v167
    v_cvt_pk_bf16_f32 v113, v168, v169
    v_cvt_pk_bf16_f32 v117, v170, v171
    buffer_load_dword v255, v251, s[40:43], s69 offen
    s_waitcnt lgkmcnt(0)
    v_dot2_f32_bf16 v168, v142, s66, 0
    v_dot2_f32_bf16 v169, v141, s67, 0
    v_dot2_f32_bf16 v170, v129, s67, 0
    v_dot2_f32_bf16 v171, v134, s66, 0
    v_dot2_f32_bf16 v168, v140, s67, v168
    v_dot2_f32_bf16 v169, v143, s66, v169
    v_dot2_f32_bf16 v170, v132, s66, v170
    v_dot2_f32_bf16 v171, v130, s67, v171
    v_cvt_pk_bf16_f32 v114, v164, v165
    v_cvt_pk_bf16_f32 v118, v166, v167
    s_nop 2
    v_cvt_pk_bf16_f32 v115, v168, v169
    v_cvt_pk_bf16_f32 v119, v170, v171
    ds_write_b128 v52, v[96:99] offset:960
    ds_write_b128 v52, v[100:103] offset:976
    ds_write_b128 v52, v[104:107] offset:832
    ds_write_b128 v52, v[108:111] offset:848
    ds_write_b128 v52, v[112:115] offset:1216
    ds_write_b128 v52, v[116:119] offset:1232
    s_waitcnt vmcnt(3)
    s_branch L_folded
L_fold3:
    ds_read_b32 v128, v50 offset:316
    ds_read_b32 v129, v50 offset:116
    ds_read_b32 v130, v50 offset:164
    ds_read_b32 v131, v50 offset:212
    ds_read_b32 v132, v50 offset:168
    ds_read_b32 v133, v50 offset:368
    ds_read_b32 v134, v50 offset:112
    ds_read_b32 v135, v50 offset:264
    ds_read_b32 v136, v50 offset:432
    ds_read_b32 v137, v50 offset:484
    ds_read_b32 v138, v50 offset:540
    ds_read_b32 v139, v50 offset:592
    ds_read_b32 v140, v50 offset:488
    ds_read_b32 v141, v50 offset:536
    ds_read_b32 v142, v50 offset:436
    ds_read_b32 v143, v50 offset:588
    s_setprio 3
    ds_read_b32 v146, v50 offset:456
    ds_read_b32 v147, v50 offset:1056
    ds_read_b32 v148, v50 offset:564
    ds_read_b32 v149, v50 offset:1164
    ds_read_b32 v150, v50 offset:508
    s_waitcnt lgkmcnt(13)
    v_dot2_f32_bf16 v164, v128, s66, 0
    v_dot2_f32_bf16 v165, v130, s66, 0
    v_dot2_f32_bf16 v166, v132, s67, 0
    v_dot2_f32_bf16 v167, v134, s67, 0
    v_dot2_f32_bf16 v164, v129, s66, v164
    v_dot2_f32_bf16 v165, v131, s67, v165
    v_dot2_f32_bf16 v166, v133, s67, v166
    v_dot2_f32_bf16 v167, v135, s66, v167
    s_add_u32 m0, s100, 1024
    v_lshl_add_u32 v57, v57, 6, v252
    buffer_load_dwordx4 v57, s[36:39], 0 offen lds
    ds_read_b32 v151, v50 offset:1108
    ds_read_b32 v152, v50 offset:616
    ds_read_b32 v153, v50 offset:1216
    ds_read_b32 v154, v50 offset:512
    ds_read_b32 v155, v50 offset:1160
    s_waitcnt lgkmcnt(15)
    v_dot2_f32_bf16 v168, v128, s67, 0
    v_lshlrev_b32 v169, 16, v136
    v_dot2_f32_bf16 v170, v129, s67, 0
    v_and_b32 v171, 0xffff0000, v137
    v_dot2_f32_bf16 v168, v132, s66, v168
    v_dot2_f32_bf16 v170, v133, s66, v170
    v_cvt_pk_bf16_f32 v96, v164, v165
    v_cvt_pk_bf16_f32 v100, v166, v167
    ds_read_b32 v156, v50 offset:1060
    ds_read_b32 v157, v50 offset:612
    ds_read_b32 v158, v50 offset:460
    ds_read_b32 v159, v50 offset:560
    ds_read_b32 v160, v50 offset:1212
    s_waitcnt lgkmcnt(15)
    v_lshlrev_b32 v164, 16, v138
    v_dot2_f32_bf16 v165, v136, s67, 0
    v_and_b32 v166, 0xffff0000, v139
    v_dot2_f32_bf16 v167, v140, s66, 0
    v_dot2_f32_bf16 v165, v137, s66, v165
    v_dot2_f32_bf16 v167, v141, s67, v167
    v_cvt_pk_bf16_f32 v97, v168, v169
    v_cvt_pk_bf16_f32 v101, v170, v171
    s_setprio 2
    ds_read_b32 v161, v50 offset:1112
    s_waitcnt lgkmcnt(15)
    v_dot2_f32_bf16 v168, v138, s67, 0
    v_dot2_f32_bf16 v169, v142, s66, 0
    v_dot2_f32_bf16 v170, v143, s66, 0
    v_dot2_f32_bf16 v171, v140, s67, 0
    v_dot2_f32_bf16 v168, v139, s66, v168
    v_dot2_f32_bf16 v169, v141, s66, v169
    v_dot2_f32_bf16 v170, v142, s67, v170
    v_dot2_f32_bf16 v171, v143, s67, v171
    v_cvt_pk_bf16_f32 v98, v164, v165
    v_cvt_pk_bf16_f32 v102, v166, v167
    ds_read_b32 v128, v50 offset:880
    ds_read_b32 v129, v50 offset:1280
    ds_read_b32 v130, v50 offset:36
    ds_read_b32 v131, v50 offset:936
    ds_read_b32 v132, v50 offset:1332
    s_waitcnt lgkmcnt(13)
    v_dot2_f32_bf16 v164, v146, s66, 0
    v_dot2_f32_bf16 v165, v148, s66, 0
    v_dot2_f32_bf16 v166, v150, s67, 0
    v_dot2_f32_bf16 v167, v152, s67, 0
    v_dot2_f32_bf16 v164, v147, s66, v164
    v_dot2_f32_bf16 v165, v149, s66, v165
    v_dot2_f32_bf16 v166, v151, s67, v166
    v_dot2_f32_bf16 v167, v153, s67, v167
    v_cvt_pk_bf16_f32 v99, v168, v169
    v_cvt_pk_bf16_f32 v103, v170, v171
    ds_read_b32 v133, v50 offset:932
    ds_read_b32 v134, v50 offset:88
    ds_read_b32 v135, v50 offset:988
    ds_read_b32 v136, v50 offset:884
    ds_read_b32 v137, v50 offset:32
    s_waitcnt lgkmcnt(14)
    v_dot2_f32_bf16 v168, v151, s66, 0
    v_dot2_f32_bf16 v169, v153, s66, 0
    v_dot2_f32_bf16 v170, v154, s66, 0
    v_dot2_f32_bf16 v171, v156, s67, 0
    v_dot2_f32_bf16 v168, v146, s67, v168
    v_dot2_f32_bf16 v169, v148, s67, v169
    v_dot2_f32_bf16 v170, v155, s67, v170
    v_dot2_f32_bf16 v171, v157, s66, v171
    v_cvt_pk_bf16_f32 v104, v164, v165
    v_cvt_pk_bf16_f32 v108, v166, v167
    s_setprio 1
    ds_read_b32 v138, v50 offset:1036
    ds_read_b32 v139, v50 offset:1284
    ds_read_b32 v140, v50 offset:832
    ds_read_b32 v141, v50 offset:984
    ds_read_b32 v142, v50 offset:84
    s_waitcnt lgkmcnt(15)
    v_dot2_f32_bf16 v164, v155, s66, 0
    v_dot2_f32_bf16 v165, v156, s66, 0
    v_dot2_f32_bf16 v166, v154, s67, 0
    v_dot2_f32_bf16 v167, v161, s67, 0
    v_dot2_f32_bf16 v164, v158, s66, v164
    v_dot2_f32_bf16 v165, v159, s66, v165
    v_dot2_f32_bf16 v166, v160, s67, v166
    v_dot2_f32_bf16 v167, v157, s67, v167
    v_cvt_pk_bf16_f32 v105, v168, v169
    v_cvt_pk_bf16_f32 v109, v170, v171
    s_add_u32 m0, s100, 2048
    v_lshl_add_u32 v58, v58, 6, v252
    buffer_load_dwordx4 v58, s[36:39], 0 offen lds
    ds_read_b32 v143, v50 offset:1336
    s_waitcnt lgkmcnt(15)
    v_dot2_f32_bf16 v168, v160, s66, 0
    v_dot2_f32_bf16 v169, v159, s67, 0
    v_dot2_f32_bf16 v170, v147, s67, 0
    v_dot2_f32_bf16 v171, v152, s66, 0
    v_dot2_f32_bf16 v168, v158, s67, v168
    v_dot2_f32_bf16 v169, v161, s66, v169
    v_dot2_f32_bf16 v170, v150, s66, v170
    v_dot2_f32_bf16 v171, v149, s67, v171
    v_cvt_pk_bf16_f32 v106, v164, v165
    v_cvt_pk_bf16_f32 v110, v166, v167
    s_waitcnt lgkmcnt(8)
    v_dot2_f32_bf16 v164, v128, s66, 0
    v_dot2_f32_bf16 v165, v130, s66, 0
    v_dot2_f32_bf16 v166, v132, s67, 0
    v_dot2_f32_bf16 v167, v134, s67, 0
    v_dot2_f32_bf16 v164, v129, s66, v164
    v_dot2_f32_bf16 v165, v131, s66, v165
    v_dot2_f32_bf16 v166, v133, s67, v166
    v_dot2_f32_bf16 v167, v135, s67, v167
    v_cvt_pk_bf16_f32 v107, v168, v169
    v_cvt_pk_bf16_f32 v111, v170, v171
    s_setprio 0
    s_waitcnt lgkmcnt(4)
    v_dot2_f32_bf16 v168, v132, s66, 0
    v_dot2_f32_bf16 v169, v134, s66, 0
    v_dot2_f32_bf16 v170, v136, s66, 0
    v_dot2_f32_bf16 v171, v138, s66, 0
    v_dot2_f32_bf16 v168, v128, s67, v168
    v_dot2_f32_bf16 v169, v131, s67, v169
    v_dot2_f32_bf16 v170, v137, s67, v170
    v_dot2_f32_bf16 v171, v139, s67, v171
    v_cvt_pk_bf16_f32 v112, v164, v165
    v_cvt_pk_bf16_f32 v116, v166, v167
    s_waitcnt lgkmcnt(0)
    v_dot2_f32_bf16 v164, v137, s66, 0
    v_dot2_f32_bf16 v165, v141, s66, 0
    v_dot2_f32_bf16 v166, v142, s67, 0
    v_dot2_f32_bf16 v167, v138, s67, 0
    v_dot2_f32_bf16 v164, v140, s66, v164
    v_dot2_f32_bf16 v165, v139, s66, v165
    v_dot2_f32_bf16 v166, v136, s67, v166
    v_dot2_f32_bf16 v167, v143, s67, v167
    v_cvt_pk_bf16_f32 v113, v168, v169
    v_cvt_pk_bf16_f32 v117, v170, v171
    s_waitcnt lgkmcnt(0)
    v_dot2_f32_bf16 v168, v142, s66, 0
    v_dot2_f32_bf16 v169, v143, s66, 0
    v_dot2_f32_bf16 v170, v133, s66, 0
    v_dot2_f32_bf16 v171, v130, s67, 0
    v_dot2_f32_bf16 v168, v140, s67, v168
    v_dot2_f32_bf16 v169, v141, s67, v169
    v_dot2_f32_bf16 v170, v129, s67, v170
    v_dot2_f32_bf16 v171, v135, s66, v171
    v_cvt_pk_bf16_f32 v114, v164, v165
    v_cvt_pk_bf16_f32 v118, v166, v167
    s_nop 2
    v_cvt_pk_bf16_f32 v115, v168, v169
    v_cvt_pk_bf16_f32 v119, v170, v171
    ds_write_b128 v52, v[96:99] offset:64
    ds_write_b128 v52, v[100:103] offset:80
    ds_write_b128 v52, v[104:107] offset:768
    ds_write_b128 v52, v[108:111] offset:784
    ds_write_b128 v52, v[112:115] offset:1280
    ds_write_b128 v52, v[116:119] offset:1296
    s_waitcnt vmcnt(2)
    s_branch L_folded
L_fold4:
    ds_read_b32 v128, v50 offset:424
    ds_read_b32 v129, v50 offset:224
    ds_read_b32 v130, v50 offset:532
    ds_read_b32 v131, v50 offset:332
    ds_read_b32 v132, v50 offset:276
    ds_read_b32 v133, v50 offset:476
    ds_read_b32 v134, v50 offset:584
    ds_read_b32 v135, v50 offset:384
    ds_read_b32 v136, v50 offset:280
    ds_read_b32 v137, v50 offset:528
    ds_read_b32 v138, v50 offset:428
    ds_read_b32 v139, v50 offset:380
    ds_read_b32 v140, v50 offset:228
    ds_read_b32 v141, v50 offset:328
    ds_read_b32 v142, v50 offset:580
    ds_read_b32 v143, v50 offset:480
    s_setprio 3
    ds_read_b32 v146, v50 offset:1048
    ds_read_b32 v147, v50 offset:248
    ds_read_b32 v148, v50 offset:356
    ds_read_b32 v149, v50 offset:1156
    ds_read_b32 v150, v50 offset:300
    s_waitcnt lgkmcnt(13)
    v_dot2_f32_bf16 v164, v128, s66, 0
    v_dot2_f32_bf16 v165, v130, s66, 0
    v_dot2_f32_bf16 v166, v132, s67, 0
    v_dot2_f32_bf16 v167, v134, s67, 0
    v_dot2_f32_bf16 v164, v129, s66, v164
    v_dot2_f32_bf16 v165, v131, s66, v165
    v_dot2_f32_bf16 v166, v133, s67, v166
    v_dot2_f32_bf16 v167, v135, s67, v167
    s_add_u32 m0, s100, 1024
    v_lshl_add_u32 v57, v57, 6, v252
    buffer_load_dwordx4 v57, s[36:39], 0 offen lds
    ds_read_b32 v151, v50 offset:1100
    ds_read_b32 v152, v50 offset:1208
    ds_read_b32 v153, v50 offset:408
    ds_read_b32 v154, v50 offset:304
    ds_read_b32 v155, v50 offset:1152
    s_waitcnt lgkmcnt(14)
    v_dot2_f32_bf16 v168, v129, s67, 0
    v_dot2_f32_bf16 v169, v134, s66, 0
    v_dot2_f32_bf16 v170, v136, s66, 0
    v_dot2_f32_bf16 v171, v138, s67, 0
    v_dot2_f32_bf16 v168, v133, s66, v168
    v_dot2_f32_bf16 v169, v131, s67, v169
    v_dot2_f32_bf16 v170, v137, s67, v170
    v_dot2_f32_bf16 v171, v139, s66, v171
    v_cvt_pk_bf16_f32 v96, v164, v165
    v_cvt_pk_bf16_f32 v100, v166, v167
    ds_read_b32 v156, v50 offset:1052
    ds_read_b32 v157, v50 offset:404
    ds_read_b32 v158, v50 offset:252
    ds_read_b32 v159, v50 offset:352
    ds_read_b32 v160, v50 offset:1204
    s_waitcnt lgkmcnt(15)
    v_dot2_f32_bf16 v164, v140, s66, 0
    v_dot2_f32_bf16 v165, v141, s66, 0
    v_dot2_f32_bf16 v166, v136, s67, 0
    v_dot2_f32_bf16 v167, v139, s67, 0
    v_dot2_f32_bf16 v164, v137, s66, v164
    v_dot2_f32_bf16 v165, v138, s66, v165
    v_dot2_f32_bf16 v166, v142, s67, v166
    v_dot2_f32_bf16 v167, v143, s67, v167
    v_cvt_pk_bf16_f32 v97, v168, v169
    v_cvt_pk_bf16_f32 v101, v170, v171
    s_setprio 2
    ds_read_b32 v161, v50 offset:1104
    s_waitcnt lgkmcnt(15)
    v_dot2_f32_bf16 v168, v140, s67, 0
    v_dot2_f32_bf16 v169, v143, s66, 0
    v_dot2_f32_bf16 v170, v128, s67, 0
    v_dot2_f32_bf16 v171, v135, s66, 0
    v_dot2_f32_bf16 v168, v142, s66, v168
    v_dot2_f32_bf16 v169, v141, s67, v169
    v_dot2_f32_bf16 v170, v132, s66, v170
    v_dot2_f32_bf16 v171, v130, s67, v171
    v_cvt_pk_bf16_f32 v98, v164, v165
    v_cvt_pk_bf16_f32 v102, v166, v167
    ds_read_b32 v128, v50 offset:1288
    ds_read_b32 v129, v50 offset:1088
    ds_read_b32 v130, v50 offset:44
    ds_read_b32 v131, v50 offset:1144
    ds_read_b32 v132, v50 offset:1140
    s_waitcnt lgkmcnt(13)
    v_dot2_f32_bf16 v164, v146, s66, 0
    v_dot2_f32_bf16 v165, v148, s66, 0
    v_dot2_f32_bf16 v166, v150, s67, 0
    v_dot2_f32_bf16 v167, v152, s67, 0
    v_dot2_f32_bf16 v164, v147, s66, v164
    v_dot2_f32_bf16 v165, v149, s66, v165
    v_dot2_f32_bf16 v166, v151, s67, v166
    v_dot2_f32_bf16 v167, v153, s67, v167
    v_cvt_pk_bf16_f32 v99, v168, v169
    v_cvt_pk_bf16_f32 v103, v170, v171
    ds_read_b32 v133, v50 offset:1340
    ds_read_b32 v134, v50 offset:96
    ds_read_b32 v135, v50 offset:1196
    ds_read_b32 v136, v50 offset:40
    ds_read_b32 v137, v50 offset:1092
    s_waitcnt lgkmcnt(14)
    v_dot2_f32_bf16 v168, v147, s67, 0
    v_dot2_f32_bf16 v169, v148, s67, 0
    v_dot2_f32_bf16 v170, v154, s66, 0
    v_dot2_f32_bf16 v171, v156, s67, 0
    v_dot2_f32_bf16 v168, v151, s66, v168
    v_dot2_f32_bf16 v169, v152, s66, v169
    v_dot2_f32_bf16 v170, v155, s67, v170
    v_dot2_f32_bf16 v171, v157, s66, v171
    v_cvt_pk_bf16_f32 v104, v164, v165
    v_cvt_pk_bf16_f32 v108, v166, v167
    s_setprio 1
    ds_read_b32 v138, v50 offset:1244
    ds_read_b32 v139, v50 offset:1292
    ds_read_b32 v140, v50 offset:1040
    ds_read_b32 v141, v50 offset:1192
    ds_read_b32 v142, v50 offset:92
    s_waitcnt lgkmcnt(15)
    v_dot2_f32_bf16 v164, v158, s66, 0
    v_dot2_f32_bf16 v165, v156, s66, 0
    v_dot2_f32_bf16 v166, v160, s67, 0
    v_dot2_f32_bf16 v167, v157, s67, 0
    v_dot2_f32_bf16 v164, v155, s66, v164
    v_dot2_f32_bf16 v165, v159, s66, v165
    v_dot2_f32_bf16 v166, v154, s67, v166
    v_dot2_f32_bf16 v167, v161, s67, v167
    v_cvt_pk_bf16_f32 v105, v168, v169
    v_cvt_pk_bf16_f32 v109, v170, v171
    s_add_u32 m0, s100, 2048
    v_lshl_add_u32 v58, v58, 6, v252
    buffer_load_dwordx4 v58, s[36:39], 0 offen lds
    ds_read_b32 v143, v50 offset:1344
    s_waitcnt lgkmcnt(15)
    v_dot2_f32_bf16 v168, v160, s66, 0
    v_dot2_f32_bf16 v169, v161, s66, 0
    v_dot2_f32_bf16 v170, v150, s66, 0
    v_dot2_f32_bf16 v171, v149, s67, 0
    v_dot2_f32_bf16 v168, v158, s67, v168
    v_dot2_f32_bf16 v169, v159, s67, v169
    v_dot2_f32_bf16 v170, v146, s67, v170
    v_dot2_f32_bf16 v171, v153, s66, v171
    v_cvt_pk_bf16_f32 v106, v164, v165
    v_cvt_pk_bf16_f32 v110, v166, v167
    s_waitcnt lgkmcnt(8)
    v_dot2_f32_bf16 v164, v128, s66, 0
    v_dot2_f32_bf16 v165, v130, s66, 0
    v_dot2_f32_bf16 v166, v132, s67, 0
    v_dot2_f32_bf16 v167, v134, s67, 0
    v_dot2_f32_bf16 v164, v129, s66, v164
    v_dot2_f32_bf16 v165, v131, s66, v165
    v_dot2_f32_bf16 v166, v133, s67, v166
    v_dot2_f32_bf16 v167, v135, s67, v167
    v_cvt_pk_bf16_f32 v107, v168, v169
    v_cvt_pk_bf16_f32 v111, v170, v171
    s_setprio 0
    s_waitcnt lgkmcnt(4)
    v_dot2_f32_bf16 v168, v133, s66, 0
    v_dot2_f32_bf16 v169, v131, s67, 0
    v_dot2_f32_bf16 v170, v136, s67, 0
    v_dot2_f32_bf16 v171, v138, s66, 0
    v_dot2_f32_bf16 v168, v129, s67, v168
    v_dot2_f32_bf16 v169, v134, s66, v169
    v_dot2_f32_bf16 v170, v137, s66, v170
    v_dot2_f32_bf16 v171, v139, s67, v171
    v_cvt_pk_bf16_f32 v112, v164, v165
    v_cvt_pk_bf16_f32 v116, v166, v167
    s_waitcnt lgkmcnt(0)
    v_dot2_f32_bf16 v164, v140, s66, 0
    v_dot2_f32_bf16 v165, v141, s66, 0
    v_dot2_f32_bf16 v166, v142, s67, 0
    v_dot2_f32_bf16 v167, v143, s67, 0
    v_dot2_f32_bf16 v164, v136, s66, v164
    v_dot2_f32_bf16 v165, v139, s66, v165
    v_dot2_f32_bf16 v166, v137, s67, v166
    v_dot2_f32_bf16 v167, v138, s67, v167
    v_cvt_pk_bf16_f32 v113, v168, v169
    v_cvt_pk_bf16_f32 v117, v170, v171
    s_waitcnt lgkmcnt(0)
    v_dot2_f32_bf16 v168, v140, s67, 0
    v_dot2_f32_bf16 v169, v143, s66, 0
    v_dot2_f32_bf16 v170, v128, s67, 0
    v_dot2_f32_bf16 v171, v130, s67, 0
    v_dot2_f32_bf16 v168, v142, s66, v168
    v_dot2_f32_bf16 v169, v141, s67, v169
    v_dot2_f32_bf16 v170, v132, s66, v170
    v_dot2_f32_bf16 v171, v135, s66, v171
    v_cvt_pk_bf16_f32 v114, v164, v165
    v_cvt_pk_bf16_f32 v118, v166, v167
    s_nop 2
    v_cvt_pk_bf16_f32 v115, v168, v169
    v_cvt_pk_bf16_f32 v119, v170, v171
    ds_write_b128 v52, v[96:99] offset:128
    ds_write_b128 v52, v[100:103] offset:144
    ds_write_b128 v52, v[104:107] offset:704
    ds_write_b128 v52, v[108:111] offset:720
    ds_write_b128 v52, v[112:115] offset:1344
    ds_write_b128 v52, v[116:119] offset:1360
    s_waitcnt vmcnt(2)
    s_branch L_folded
L_fold5:
    ds_read_b32 v128, v50 offset:420
    ds_read_b32 v129, v50 offset:120
    ds_read_b32 v130, v50 offset:124
    ds_read_b32 v131, v50 offset:524
    ds_read_b32 v132, v50 offset:172
    ds_read_b32 v133, v50 offset:472
    ds_read_b32 v134, v50 offset:576
    ds_read_b32 v135, v50 offset:176
    ds_read_b32 v136, v50 offset:648
    ds_read_b32 v137, v50 offset:756
    ds_read_b32 v138, v50 offset:700
    ds_read_b32 v139, v50 offset:808
    ds_read_b32 v140, v50 offset:704
    ds_read_b32 v141, v50 offset:752
    ds_read_b32 v142, v50 offset:804
    ds_read_b32 v143, v50 offset:652
    s_setprio 3
    ds_read_b32 v146, v50 offset:656
    ds_read_b32 v147, v50 offset:856
    ds_read_b32 v148, v50 offset:764
    ds_read_b32 v149, v50 offset:964
    ds_read_b32 v150, v50 offset:908
    s_waitcnt lgkmcnt(13)
    v_dot2_f32_bf16 v164, v128, s66, 0
    v_dot2_f32_bf16 v165, v130, s66, 0
    v_dot2_f32_bf16 v166, v132, s67, 0
    v_dot2_f32_bf16 v167, v134, s67, 0
    v_dot2_f32_bf16 v164, v129, s66, v164
    v_dot2_f32_bf16 v165, v131, s66, v165
    v_dot2_f32_bf16 v166, v133, s67, v166
    v_dot2_f32_bf16 v167, v135, s67, v167
    s_add_u32 m0, s100, 1024
    v_lshl_add_u32 v57, v57, 6, v252
    buffer_load_dwordx4 v57, s[36:39], 0 offen lds
    ds_read_b32 v151, v50 offset:708
    ds_read_b32 v152, v50 offset:1016
    ds_read_b32 v153, v50 offset:816
    ds_read_b32 v154, v50 offset:960
    ds_read_b32 v155, v50 offset:712
    s_waitcnt lgkmcnt(15)
    v_dot2_f32_bf16 v168, v128, s67, 0
    v_dot2_f32_bf16 v169, v135, s66, 0
    v_dot2_f32_bf16 v170, v129, s67, 0
    v_dot2_f32_bf16 v171, v134, s66, 0
    v_dot2_f32_bf16 v168, v132, s66, v168
    v_dot2_f32_bf16 v169, v131, s67, v169
    v_dot2_f32_bf16 v170, v133, s66, v170
    v_dot2_f32_bf16 v171, v130, s67, v171
    v_cvt_pk_bf16_f32 v96, v164, v165
    v_cvt_pk_bf16_f32 v100, v166, v167
    ds_read_b32 v156, v50 offset:812
    ds_read_b32 v157, v50 offset:860
    ds_read_b32 v158, v50 offset:660
    ds_read_b32 v159, v50 offset:760
    ds_read_b32 v160, v50 offset:1012
    s_waitcnt lgkmcnt(15)
    v_lshlrev_b32 v164, 16, v136
    v_lshlrev_b32 v165, 16, v137
    v_and_b32 v166, 0xffff0000, v138
    v_and_b32 v167, 0xffff0000, v139
    v_cvt_pk_bf16_f32 v97, v168, v169
    v_cvt_pk_bf16_f32 v101, v170, v171
    s_setprio 2
    ds_read_b32 v161, v50 offset:912
    s_waitcnt lgkmcnt(15)
    v_dot2_f32_bf16 v168, v136, s67, 0
    v_dot2_f32_bf16 v169, v137, s67, 0
    v_dot2_f32_bf16 v170, v140, s66, 0
    v_dot2_f32_bf16 v171, v142, s66, 0
    v_dot2_f32_bf16 v168, v138, s66, v168
    v_dot2_f32_bf16 v169, v139, s66, v169
    v_dot2_f32_bf16 v170, v141, s67, v170
    v_dot2_f32_bf16 v171, v143, s67, v171
    v_cvt_pk_bf16_f32 v98, v164, v165
    v_cvt_pk_bf16_f32 v102, v166, v167
    ds_read_b32 v128, v50 offset:108
    ds_read_b32 v129, v50 offset:160
    ds_read_b32 v130, v50 offset:216
    ds_read_b32 v131, v50 offset:324
    ds_read_b32 v132, v50 offset:268
    s_waitcnt lgkmcnt(13)
    v_dot2_f32_bf16 v164, v146, s66, 0
    v_dot2_f32_bf16 v165, v148, s66, 0
    v_dot2_f32_bf16 v166, v150, s67, 0
    v_dot2_f32_bf16 v167, v152, s67, 0
    v_dot2_f32_bf16 v164, v147, s66, v164
    v_dot2_f32_bf16 v165, v149, s66, v165
    v_dot2_f32_bf16 v166, v151, s67, v166
    v_dot2_f32_bf16 v167, v153, s67, v167
    v_cvt_pk_bf16_f32 v99, v168, v169
    v_cvt_pk_bf16_f32 v103, v170, v171
    ds_read_b32 v133, v50 offset:376
    ds_read_b32 v134, v50 offset:272
    ds_read_b32 v135, v50 offset:320
    ds_read_b32 v136, v50 offset:372
    ds_read_b32 v137, v50 offset:220
    s_waitcnt lgkmcnt(14)
    v_dot2_f32_bf16 v168, v146, s67, 0
    v_dot2_f32_bf16 v169, v152, s66, 0
    v_dot2_f32_bf16 v170, v154, s67, 0
    v_dot2_f32_bf16 v171, v156, s66, 0
    v_dot2_f32_bf16 v168, v150, s66, v168
    v_dot2_f32_bf16 v169, v148, s67, v169
    v_dot2_f32_bf16 v170, v155, s66, v170
    v_dot2_f32_bf16 v171, v157, s67, v171
    v_cvt_pk_bf16_f32 v104, v164, v165
    v_cvt_pk_bf16_f32 v108, v166, v167
    s_setprio 1
    ds_read_b32 v138, v50 offset:112
    ds_read_b32 v139, v50 offset:212
    ds_read_b32 v140, v50 offset:264
    ds_read_b32 v141, v50 offset:164
    s_waitcnt lgkmcnt(14)
    v_dot2_f32_bf16 v164, v158, s66, 0
    v_dot2_f32_bf16 v165, v157, s66, 0
    v_dot2_f32_bf16 v166, v155, s67, 0
    v_dot2_f32_bf16 v167, v156, s67, 0
    v_dot2_f32_bf16 v164, v154, s66, v164
    v_dot2_f32_bf16 v165, v159, s66, v165
    v_dot2_f32_bf16 v166, v160, s67, v166
    v_dot2_f32_bf16 v167, v161, s67, v167
    v_cvt_pk_bf16_f32 v105, v168, v169
    v_cvt_pk_bf16_f32 v109, v170, v171
    s_add_u32 m0, s100, 2048
    v_lshl_add_u32 v58, v58, 6, v252
    buffer_load_dwordx4 v58, s[36:39], 0 offen lds
    s_waitcnt lgkmcnt(14)
    v_dot2_f32_bf16 v168, v158, s67, 0
    v_dot2_f32_bf16 v169, v161, s66, 0
    v_dot2_f32_bf16 v170, v147, s67, 0
    v_dot2_f32_bf16 v171, v149, s67, 0
    v_dot2_f32_bf16 v168, v160, s66, v168
    v_dot2_f32_bf16 v169, v159, s67, v169
    v_dot2_f32_bf16 v170, v151, s66, v170
    v_dot2_f32_bf16 v171, v153, s66, v171
    v_cvt_pk_bf16_f32 v106, v164, v165
    v_cvt_pk_bf16_f32 v110, v166, v167
    s_waitcnt lgkmcnt(12)
    v_lshlrev_b32 v164, 16, v128
    v_dot2_f32_bf16 v165, v128, s67, 0
    v_and_b32 v166, 0xffff0000, v129
    v_dot2_f32_bf16 v165, v129, s66, v165
    v_cvt_pk_bf16_f32 v107, v168, v169
    v_cvt_pk_bf16_f32 v111, v170, v171
    s_setprio 0
    s_waitcnt lgkmcnt(8)
    v_lshlrev_b32 v168, 16, v130
    v_lshlrev_b32 v169, 16, v131
    v_and_b32 v170, 0xffff0000, v132
    v_and_b32 v171, 0xffff0000, v133
    v_cvt_pk_bf16_f32 v112, v164, v165
    v_cvt_pk_bf16_f32 v116, v166, 0
    s_waitcnt lgkmcnt(4)
    v_dot2_f32_bf16 v164, v130, s67, 0
    v_dot2_f32_bf16 v165, v131, s67, 0
    v_dot2_f32_bf16 v166, v134, s66, 0
    v_dot2_f32_bf16 v167, v136, s66, 0
    v_dot2_f32_bf16 v164, v132, s66, v164
    v_dot2_f32_bf16 v165, v133, s66, v165
    v_dot2_f32_bf16 v166, v135, s67, v166
    v_dot2_f32_bf16 v167, v137, s67, v167
    v_cvt_pk_bf16_f32 v113, v168, v169
    v_cvt_pk_bf16_f32 v117, v170, v171
    s_waitcnt lgkmcnt(0)
    v_dot2_f32_bf16 v168, v137, s66, 0
    v_dot2_f32_bf16 v169, v138, s66, 0
    v_dot2_f32_bf16 v170, v136, s67, 0
    v_dot2_f32_bf16 v171, v140, s67, 0
    v_dot2_f32_bf16 v168, v135, s66, v168
    v_dot2_f32_bf16 v169, v139, s66, v169
    v_dot2_f32_bf16 v170, v134, s67, v170
    v_dot2_f32_bf16 v171, v141, s67, v171
    v_cvt_pk_bf16_f32 v114, v164, v165
    v_cvt_pk_bf16_f32 v118, v166, v167
    s_nop 2
    v_cvt_pk_bf16_f32 v115, v168, v169
    v_cvt_pk_bf16_f32 v119, v170, v171
    ds_write_b128 v52, v[96:99] offset:192
    ds_write_b128 v52, v[100:103] offset:208
    ds_write_b128 v52, v[104:107] offset:576
    ds_write_b128 v52, v[108:111] offset:592
    ds_write_b128 v52, v[112:115] offset:0
    ds_write_b128 v52, v[116:119] offset:16
    s_waitcnt vmcnt(2)
    s_branch L_folded
L_folded:
    ds_read_u16_d16_hi v64, v212 offset:0
    ds_read_u16_d16_hi v65, v212 offset:128
    ds_read_u16_d16_hi v66, v212 offset:256
    ds_read_u16_d16_hi v67, v213 offset:0
    ds_read_u16_d16_hi v88, v212 offset:3072
    ds_read_u16_d16_hi v89, v214 offset:3072
    ds_read_u16_d16_hi v90, v212 offset:64
    ds_read_u16_d16_hi v91, v212 offset:192
    ds_read_u16_d16_hi v92, v212 offset:320
    ds_read_u16_d16_hi v93, v213 offset:64
    ds_read_u16_d16_hi v238, v212 offset:3136
    ds_read_u16_d16_hi v239, v214 offset:3136
    ds_read_u16_d16_hi v68, v212 offset:512
    ds_read_u16_d16_hi v69, v212 offset:640
    ds_read_u16_d16_hi v70, v212 offset:768
    v_lshl_add_u32 v232, v61, 6, v252
    v_lshl_add_u32 v233, v62, 6, v252
    v_lshl_add_u32 v234, v63, 6, v252
    s_lshl_b32 s31, s29, 2
    s_mov_b32 s67, s26
    s_mov_b32 s101, 0
    s_mov_b32 vcc_lo, 67108863
    s_mov_b32 vcc_hi, 67108863
    s_waitcnt lgkmcnt(9)
    v_mul_f32 v96, v88, v88
    v_mul_f32 v97, v88, v89
    v_mul_f32 v98, v64, v64
    v_mul_f32 v99, v66, v66
    v_cvt_pk_bf16_f32 v104, v96, v97
    v_cvt_pk_bf16_f32 v105, v98, v99
    v_mul_f32 v100, v64, v65
    v_mul_f32 v101, v66, v67
    v_mul_f32 v102, v64, v66
    v_mul_f32 v103, v64, v88
    v_cvt_pk_bf16_f32 v106, v100, v101
    v_cvt_pk_bf16_f32 v107, v102, v103
    s_waitcnt lgkmcnt(3)
    v_mul_f32 v96, v238, v238
    v_mul_f32 v97, v238, v239
    v_mul_f32 v98, v90, v90
    v_mul_f32 v99, v92, v92
    v_cvt_pk_bf16_f32 v112, v96, v97
    v_cvt_pk_bf16_f32 v113, v98, v99
    v_mul_f32 v100, v90, v91
    v_mul_f32 v101, v92, v93
    v_mul_f32 v102, v90, v92
    v_mul_f32 v103, v90, v238
    v_cvt_pk_bf16_f32 v114, v100, v101
    v_cvt_pk_bf16_f32 v115, v102, v103
    s_barrier
    ds_read_b128 v[120:123], v215 offset:0
    ds_read_b128 v[124:127], v215 offset:32
    ds_read_u16_d16_hi v71, v213 offset:512
    ds_read_u16_d16_hi v94, v212 offset:576
    ds_read_u16_d16_hi v95, v212 offset:704
    ds_read_u16_d16_hi v216, v212 offset:832
    ds_read_u16_d16_hi v217, v213 offset:576
    s_waitcnt lgkmcnt(0)
L_cloop:
    v_mfma_f32_32x32x16_bf16 v[144:159], v[104:107], v[120:123], 0
    s_setprio 0
    ds_read_b128 v[128:131], v215 offset:64
    ds_read_b128 v[132:135], v215 offset:96
    v_mul_f32 v36, v176, v192
    s_setprio 1
    v_mul_f32 v37, v177, v193
    v_fmac_f32 v36, v178, v194
    v_fmac_f32 v37, v179, v195
    v_fmac_f32 v36, v180, v196
    v_fmac_f32 v37, v181, v197
    v_fmac_f32 v36, v182, v198
    v_fmac_f32 v37, v183, v199
    v_fmac_f32 v36, v184, v200
    v_mfma_f32_32x32x16_bf16 v[160:175], v[104:107], v[124:127], 0
    s_setprio 0
    s_waitcnt vmcnt(1)
    ds_read_u16_d16_hi v72, v212 offset:1024
    ds_read_u16_d16_hi v73, v212 offset:1152
    v_fmac_f32 v37, v185, v201
    s_setprio 1
    v_fmac_f32 v36, v186, v202
    v_fmac_f32 v37, v187, v203
    v_fmac_f32 v36, v188, v204
    v_fmac_f32 v37, v189, v205
    v_fmac_f32 v36, v190, v206
    v_fmac_f32 v37, v191, v207
    v_add_f32 v36, v36, v37
    v_cndmask_b32 v241, 0, v36, vcc
    v_mul_f32 v96, v66, v88
    v_mul_f32 v97, v64, v89
    v_mfma_f32_32x32x16_bf16 v[176:191], v[112:115], v[120:123], 0
    s_setprio 0
    ds_read_u16_d16_hi v74, v212 offset:1280
    ds_read_u16_d16_hi v75, v213 offset:1024
    v_mul_f32 v98, v66, v89
    s_setprio 1
    v_mul_f32 v99, v68, v68
    v_cvt_pk_bf16_f32 v108, v96, v97
    v_cvt_pk_bf16_f32 v109, v98, v99
    v_mul_f32 v100, v70, v70
    v_mul_f32 v101, v68, v69
    v_mul_f32 v102, v70, v71
    v_mul_f32 v103, v68, v70
    v_cvt_pk_bf16_f32 v110, v100, v101
    v_cvt_pk_bf16_f32 v111, v102, v103
    v_mfma_f32_32x32x16_bf16 v[192:207], v[112:115], v[124:127], 0
    s_setprio 0
    ds_read_u16_d16_hi v218, v212 offset:1088
    ds_read_u16_d16_hi v219, v212 offset:1216
    v_mul_f32 v96, v92, v238
    s_setprio 1
    v_mul_f32 v97, v90, v239
    v_mul_f32 v98, v92, v239
    v_mul_f32 v99, v94, v94
    v_cvt_pk_bf16_f32 v116, v96, v97
    v_cvt_pk_bf16_f32 v117, v98, v99
    v_mul_f32 v100, v216, v216
    v_mul_f32 v101, v94, v95
    v_mul_f32 v102, v216, v217
    v_mul_f32 v103, v94, v216
    v_cvt_pk_bf16_f32 v118, v100, v101
    v_cvt_pk_bf16_f32 v119, v102, v103
    s_waitcnt lgkmcnt(6)
    v_mfma_f32_32x32x16_bf16 v[144:159], v[108:111], v[128:131], v[144:159]
    s_setprio 0
    ds_read_b128 v[120:123], v215 offset:128
    ds_read_b128 v[124:127], v215 offset:160
    v_mul_f32 v96, v64, v68
    s_setprio 1
    v_mul_f32 v97, v66, v70
    v_mul_f32 v98, v64, v69
    v_mul_f32 v99, v66, v71
    v_cvt_pk_bf16_f32 v104, v96, v97
    v_cvt_pk_bf16_f32 v105, v98, v99
    v_mfma_f32_32x32x16_bf16 v[176:191], v[116:119], v[128:131], v[176:191]
    s_setprio 0
    ds_read_u16_d16_hi v220, v212 offset:1344
    ds_read_u16_d16_hi v221, v213 offset:1088
    v_mul_f32 v100, v64, v70
    s_setprio 1
    v_mul_f32 v101, v66, v68
    v_mul_f32 v102, v64, v71
    v_mul_f32 v103, v66, v69
    v_cvt_pk_bf16_f32 v106, v100, v101
    v_cvt_pk_bf16_f32 v107, v102, v103
    v_mfma_f32_32x32x16_bf16 v[192:207], v[116:119], v[132:135], v[192:207]
    s_setprio 0
    s_cmp_lt_u32 s67, 8
    s_cbranch_scc0 L_site1
    s_add_u32 m0, s100, 27776
    s_nop 0
    buffer_load_dwordx4 v232, s[36:39], 0 offen lds
L_site1:
    v_mul_f32 v96, v90, v94
    s_setprio 1
    v_mul_f32 v97, v92, v216
    v_mul_f32 v98, v90, v95
    v_mul_f32 v99, v92, v217
    v_cvt_pk_bf16_f32 v112, v96, v97
    v_cvt_pk_bf16_f32 v113, v98, v99
    v_mfma_f32_32x32x16_bf16 v[160:175], v[108:111], v[132:135], v[160:175]
    s_setprio 0
    v_mul_f32 v100, v90, v216
    s_setprio 1
    v_mul_f32 v101, v92, v94
    v_mul_f32 v102, v90, v217
    v_mul_f32 v103, v92, v95
    v_cvt_pk_bf16_f32 v114, v100, v101
    v_cvt_pk_bf16_f32 v115, v102, v103
    s_waitcnt lgkmcnt(0)
    v_mfma_f32_32x32x16_bf16 v[144:159], v[104:107], v[120:123], v[144:159]
    s_setprio 0
    ds_read_b128 v[128:131], v215 offset:192
    ds_read_b128 v[132:135], v215 offset:224
    v_mul_f32 v96, v68, v88
    s_setprio 1
    v_mul_f32 v97, v70, v88
    v_mul_f32 v98, v68, v89
    v_mul_f32 v99, v70, v89
    v_cvt_pk_bf16_f32 v108, v96, v97
    v_cvt_pk_bf16_f32 v109, v98, v99
    v_mfma_f32_32x32x16_bf16 v[176:191], v[112:115], v[120:123], v[176:191]
    s_setprio 0
    s_cmp_lt_u32 s67, 8
    s_cbranch_scc0 L_site2
    s_add_u32 m0, s100, 28800
    s_nop 0
    buffer_load_dwordx4 v233, s[36:39], 0 offen lds
L_site2:
    v_mul_f32 v100, v72, v72
    s_setprio 1
    v_mul_f32 v101, v74, v74
    v_mul_f32 v102, v72, v73
    v_mul_f32 v103, v74, v75
    v_cvt_pk_bf16_f32 v110, v100, v101
    v_cvt_pk_bf16_f32 v111, v102, v103
    v_mfma_f32_32x32x16_bf16 v[192:207], v[112:115], v[124:127], v[192:207]
    s_setprio 0
    s_cmp_eq_u32 s67, 3
    s_cbranch_scc0 L_site3
    buffer_load_dword v255, v251, s[40:43], s69 offen
L_site3:
    v_mul_f32 v96, v94, v238
    s_setprio 1
    v_mul_f32 v97, v216, v238
    v_mul_f32 v98, v94, v239
    v_mul_f32 v99, v216, v239
    v_cvt_pk_bf16_f32 v116, v96, v97
    v_cvt_pk_bf16_f32 v117, v98, v99
    v_mfma_f32_32x32x16_bf16 v[160:175], v[104:107], v[124:127], v[160:175]
    s_setprio 0
    s_cmp_lt_u32 s67, 8
    s_cbranch_scc0 L_site4
    global_load_short_d16_hi v247, v3, s[18:19]
L_site4:
    v_mul_f32 v100, v218, v218
    s_setprio 1
    v_mul_f32 v101, v220, v220
    v_mul_f32 v102, v218, v219
    v_mul_f32 v103, v220, v221
    v_cvt_pk_bf16_f32 v118, v100, v101
    v_cvt_pk_bf16_f32 v119, v102, v103
    s_waitcnt lgkmcnt(0)
    v_mfma_f32_32x32x16_bf16 v[144:159], v[108:111], v[128:131], v[144:159]
    s_setprio 0
    ds_read_b128 v[120:123], v215 offset:256
    ds_read_b128 v[124:127], v215 offset:288
    v_mul_f32 v96, v64, v72
    s_setprio 1
    v_mul_f32 v97, v66, v74
    v_mul_f32 v98, v64, v73
    v_mul_f32 v99, v66, v75
    v_cvt_pk_bf16_f32 v104, v96, v97
    v_cvt_pk_bf16_f32 v105, v98, v99
    v_mfma_f32_32x32x16_bf16 v[176:191], v[116:119], v[128:131], v[176:191]
    s_setprio 0
    ds_read_u16_d16_hi v76, v212 offset:1536
    ds_read_u16_d16_hi v77, v212 offset:1664
    v_mul_f32 v100, v64, v74
    s_setprio 1
    v_mul_f32 v101, v66, v72
    v_mul_f32 v102, v64, v75
    v_mul_f32 v103, v66, v73
    v_cvt_pk_bf16_f32 v106, v100, v101
    v_cvt_pk_bf16_f32 v107, v102, v103
    v_mfma_f32_32x32x16_bf16 v[192:207], v[116:119], v[132:135], v[192:207]
    s_setprio 0
    ds_read_u16_d16_hi v78, v212 offset:1792
    ds_read_u16_d16_hi v222, v212 offset:1600
    v_mul_f32 v96, v90, v218
    s_setprio 1
    v_mul_f32 v97, v92, v220
    v_mul_f32 v98, v90, v219
    v_mul_f32 v99, v92, v221
    v_cvt_pk_bf16_f32 v112, v96, v97
    v_cvt_pk_bf16_f32 v113, v98, v99
    v_mfma_f32_32x32x16_bf16 v[160:175], v[108:111], v[132:135], v[160:175]
    s_setprio 0
    v_mul_f32 v100, v90, v220
    s_setprio 1
    v_mul_f32 v101, v92, v218
    v_mul_f32 v102, v90, v221
    v_mul_f32 v103, v92, v219
    v_cvt_pk_bf16_f32 v114, v100, v101
    v_cvt_pk_bf16_f32 v115, v102, v103
    s_waitcnt lgkmcnt(4)
    v_mfma_f32_32x32x16_bf16 v[144:159], v[104:107], v[120:123], v[144:159]
    s_setprio 0
    ds_read_b128 v[128:131], v215 offset:320
    ds_read_b128 v[132:135], v215 offset:352
    v_mul_f32 v96, v68, v72
    s_setprio 1
    v_mul_f32 v97, v70, v74
    v_mul_f32 v98, v68, v73
    v_mul_f32 v99, v70, v75
    v_cvt_pk_bf16_f32 v108, v96, v97
    v_cvt_pk_bf16_f32 v109, v98, v99
    v_mfma_f32_32x32x16_bf16 v[176:191], v[112:115], v[120:123], v[176:191]
    s_setprio 0
    ds_read_u16_d16_hi v223, v212 offset:1728
    ds_read_u16_d16_hi v224, v212 offset:1856
    v_mul_f32 v100, v68, v74
    s_setprio 1
    v_mul_f32 v101, v70, v72
    v_mul_f32 v102, v68, v75
    v_mul_f32 v103, v70, v73
    v_cvt_pk_bf16_f32 v110, v100, v101
    v_cvt_pk_bf16_f32 v111, v102, v103
    v_mfma_f32_32x32x16_bf16 v[192:207], v[112:115], v[124:127], v[192:207]
    s_setprio 0
    ds_read_u16_d16_hi v79, v213 offset:1536
    ds_read_u16_d16_hi v225, v213 offset:1600
    v_mul_f32 v96, v94, v218
    s_setprio 1
    v_mul_f32 v97, v216, v220
    v_mul_f32 v98, v94, v219
    v_mul_f32 v99, v216, v221
    v_cvt_pk_bf16_f32 v116, v96, v97
    v_cvt_pk_bf16_f32 v117, v98, v99
    v_mfma_f32_32x32x16_bf16 v[160:175], v[104:107], v[124:127], v[160:175]
    s_setprio 0
    s_cmp_lt_u32 s67, 8
    s_cbranch_scc0 L_site5
    s_add_u32 m0, s100, 29824
    s_nop 0
    s_mov_b64 exec, 0xffff
    buffer_load_dwordx4 v234, s[36:39], 0 offen lds
    s_mov_b64 exec, -1
L_site5:
    v_mul_f32 v100, v94, v220
    s_setprio 1
    v_mul_f32 v101, v216, v218
    v_mul_f32 v102, v94, v221
    v_mul_f32 v103, v216, v219
    v_cvt_pk_bf16_f32 v118, v100, v101
    v_cvt_pk_bf16_f32 v119, v102, v103
    s_waitcnt lgkmcnt(2)
    v_mfma_f32_32x32x16_bf16 v[144:159], v[108:111], v[128:131], v[144:159]
    s_setprio 0
    ds_read_b128 v[120:123], v215 offset:384
    ds_read_b128 v[124:127], v215 offset:416
    v_mul_f32 v96, v72, v74
    s_setprio 1
    v_mul_f32 v97, v72, v88
    v_mul_f32 v98, v74, v88
    v_mul_f32 v99, v72, v89
    v_cvt_pk_bf16_f32 v104, v96, v97
    v_cvt_pk_bf16_f32 v105, v98, v99
    v_mfma_f32_32x32x16_bf16 v[176:191], v[116:119], v[128:131], v[176:191]
    s_setprio 0
    s_cmp_eq_u32 s67, 4
    s_cbranch_scc0 L_site6
    buffer_load_dword v255, v251, s[40:43], s69 offen
L_site6:
    v_mul_f32 v100, v74, v89
    s_setprio 1
    v_mul_f32 v101, v76, v76
    v_mul_f32 v102, v78, v78
    v_mul_f32 v103, v76, v77
    v_cvt_pk_bf16_f32 v106, v100, v101
    v_cvt_pk_bf16_f32 v107, v102, v103
    v_mfma_f32_32x32x16_bf16 v[192:207], v[116:119], v[132:135], v[192:207]
    s_setprio 0
    v_mul_f32 v96, v218, v220
    s_setprio 1
    v_mul_f32 v97, v218, v238
    v_mul_f32 v98, v220, v238
    v_mul_f32 v99, v218, v239
    v_cvt_pk_bf16_f32 v112, v96, v97
    v_cvt_pk_bf16_f32 v113, v98, v99
    v_mfma_f32_32x32x16_bf16 v[160:175], v[108:111], v[132:135], v[160:175]
    s_setprio 0
    v_mul_f32 v100, v220, v239
    s_setprio 1
    v_mul_f32 v101, v222, v222
    v_mul_f32 v102, v224, v224
    v_mul_f32 v103, v222, v223
    v_cvt_pk_bf16_f32 v114, v100, v101
    v_cvt_pk_bf16_f32 v115, v102, v103
    s_waitcnt lgkmcnt(0)
    v_mfma_f32_32x32x16_bf16 v[144:159], v[104:107], v[120:123], v[144:159]
    s_setprio 0
    ds_read_b128 v[128:131], v215 offset:448
    ds_read_b128 v[132:135], v215 offset:480
    v_mul_f32 v96, v64, v76
    s_setprio 1
    v_mul_f32 v97, v66, v78
    v_mul_f32 v98, v64, v77
    v_mul_f32 v99, v66, v79
    v_cvt_pk_bf16_f32 v108, v96, v97
    v_cvt_pk_bf16_f32 v109, v98, v99
    v_mfma_f32_32x32x16_bf16 v[176:191], v[112:115], v[120:123], v[176:191]
    s_setprio 0
    s_cmp_eq_u32 s67, 5
    s_cbranch_scc0 L_site7
    buffer_load_dword v255, v251, s[40:43], s69 offen
L_site7:
    v_mul_f32 v100, v64, v78
    s_setprio 1
    v_mul_f32 v101, v66, v76
    v_mul_f32 v102, v64, v79
    v_mul_f32 v103, v66, v77
    v_cvt_pk_bf16_f32 v110, v100, v101
    v_cvt_pk_bf16_f32 v111, v102, v103
    v_mfma_f32_32x32x16_bf16 v[192:207], v[112:115], v[124:127], v[192:207]
    s_setprio 0
    v_mul_f32 v96, v90, v222
    s_setprio 1
    v_mul_f32 v97, v92, v224
    v_mul_f32 v98, v90, v223
    v_mul_f32 v99, v92, v225
    v_cvt_pk_bf16_f32 v116, v96, v97
    v_cvt_pk_bf16_f32 v117, v98, v99
    v_mfma_f32_32x32x16_bf16 v[160:175], v[104:107], v[124:127], v[160:175]
    s_setprio 0
    v_mul_f32 v100, v90, v224
    s_setprio 1
    v_mul_f32 v101, v92, v222
    v_mul_f32 v102, v90, v225
    v_mul_f32 v103, v92, v223
    v_cvt_pk_bf16_f32 v118, v100, v101
    v_cvt_pk_bf16_f32 v119, v102, v103
    s_waitcnt lgkmcnt(0)
    v_mfma_f32_32x32x16_bf16 v[144:159], v[108:111], v[128:131], v[144:159]
    s_setprio 0
    ds_read_b128 v[120:123], v215 offset:512
    ds_read_b128 v[124:127], v215 offset:544
    v_mul_f32 v96, v68, v76
    s_setprio 1
    v_mul_f32 v97, v70, v78
    v_mul_f32 v98, v68, v77
    v_mul_f32 v99, v70, v79
    v_cvt_pk_bf16_f32 v104, v96, v97
    v_cvt_pk_bf16_f32 v105, v98, v99
    v_mfma_f32_32x32x16_bf16 v[176:191], v[116:119], v[128:131], v[176:191]
    s_setprio 0
    s_waitcnt vmcnt(3)
    ds_read_u16_d16_hi v80, v212 offset:2048
    ds_read_u16_d16_hi v82, v212 offset:2304
    v_mul_f32 v100, v68, v78
    s_setprio 1
    v_mul_f32 v101, v70, v76
    v_mul_f32 v102, v68, v79
    v_mul_f32 v103, v70, v77
    v_cvt_pk_bf16_f32 v106, v100, v101
    v_cvt_pk_bf16_f32 v107, v102, v103
    v_mfma_f32_32x32x16_bf16 v[192:207], v[116:119], v[132:135], v[192:207]
    s_setprio 0
    ds_read_u16_d16_hi v226, v212 offset:2112
    ds_read_u16_d16_hi v228, v212 offset:2368
    v_mul_f32 v96, v94, v222
    s_setprio 1
    v_mul_f32 v97, v216, v224
    v_mul_f32 v98, v94, v223
    v_mul_f32 v99, v216, v225
    v_cvt_pk_bf16_f32 v112, v96, v97
    v_cvt_pk_bf16_f32 v113, v98, v99
    v_mfma_f32_32x32x16_bf16 v[160:175], v[108:111], v[132:135], v[160:175]
    s_setprio 0
    v_mul_f32 v100, v94, v224
    s_setprio 1
    v_mul_f32 v101, v216, v222
    v_mul_f32 v102, v94, v225
    v_mul_f32 v103, v216, v223
    v_cvt_pk_bf16_f32 v114, v100, v101
    v_cvt_pk_bf16_f32 v115, v102, v103
    s_waitcnt lgkmcnt(4)
    v_mfma_f32_32x32x16_bf16 v[144:159], v[104:107], v[120:123], v[144:159]
    s_setprio 0
    ds_read_b128 v[128:131], v215 offset:576
    ds_read_b128 v[132:135], v215 offset:608
    v_mul_f32 v96, v72, v76
    s_setprio 1
    v_mul_f32 v97, v74, v78
    v_mul_f32 v98, v72, v77
    v_mul_f32 v99, v74, v79
    v_cvt_pk_bf16_f32 v108, v96, v97
    v_cvt_pk_bf16_f32 v109, v98, v99
    v_mfma_f32_32x32x16_bf16 v[176:191], v[112:115], v[120:123], v[176:191]
    s_setprio 0
    ds_read_u16_d16_hi v81, v212 offset:2176
    ds_read_u16_d16_hi v83, v213 offset:2048
    v_mul_f32 v100, v72, v78
    s_setprio 1
    v_mul_f32 v101, v74, v76
    v_mul_f32 v102, v72, v79
    v_mul_f32 v103, v74, v77
    v_cvt_pk_bf16_f32 v110, v100, v101
    v_cvt_pk_bf16_f32 v111, v102, v103
    v_mfma_f32_32x32x16_bf16 v[192:207], v[112:115], v[124:127], v[192:207]
    s_setprio 0
    ds_read_u16_d16_hi v227, v212 offset:2240
    ds_read_u16_d16_hi v229, v213 offset:2112
    v_mul_f32 v96, v218, v222
    s_setprio 1
    v_mul_f32 v97, v220, v224
    v_mul_f32 v98, v218, v223
    v_mul_f32 v99, v220, v225
    v_cvt_pk_bf16_f32 v116, v96, v97
    v_cvt_pk_bf16_f32 v117, v98, v99
    v_mfma_f32_32x32x16_bf16 v[160:175], v[104:107], v[124:127], v[160:175]
    s_setprio 0
    v_mul_f32 v100, v218, v224
    s_setprio 1
    v_mul_f32 v101, v220, v222
    v_mul_f32 v102, v218, v225
    v_mul_f32 v103, v220, v223
    v_cvt_pk_bf16_f32 v118, v100, v101
    v_cvt_pk_bf16_f32 v119, v102, v103
    s_waitcnt lgkmcnt(4)
    v_mfma_f32_32x32x16_bf16 v[144:159], v[108:111], v[128:131], v[144:159]
    s_setprio 0
    ds_read_b128 v[120:123], v215 offset:640
    ds_read_b128 v[124:127], v215 offset:672
    v_mul_f32 v96, v78, v79
    s_setprio 1
    v_mul_f32 v97, v76, v78
    v_mul_f32 v98, v76, v88
    v_mul_f32 v99, v78, v88
    v_cvt_pk_bf16_f32 v104, v96, v97
    v_cvt_pk_bf16_f32 v105, v98, v99
    v_mfma_f32_32x32x16_bf16 v[176:191], v[116:119], v[128:131], v[176:191]
    s_setprio 0
    s_cmp_eq_u32 s67, 6
    s_cbranch_scc0 L_site8
    buffer_load_dword v255, v251, s[40:43], s69 offen
L_site8:
    v_mul_f32 v100, v76, v89
    s_setprio 1
    v_mul_f32 v101, v78, v89
    v_mul_f32 v102, v80, v80
    v_mul_f32 v103, v82, v82
    v_cvt_pk_bf16_f32 v106, v100, v101
    v_cvt_pk_bf16_f32 v107, v102, v103
    v_mfma_f32_32x32x16_bf16 v[192:207], v[116:119], v[132:135], v[192:207]
    s_setprio 0
    v_mul_f32 v96, v224, v225
    s_setprio 1
    v_mul_f32 v97, v222, v224
    v_mul_f32 v98, v222, v238
    v_mul_f32 v99, v224, v238
    v_cvt_pk_bf16_f32 v112, v96, v97
    v_cvt_pk_bf16_f32 v113, v98, v99
    v_mfma_f32_32x32x16_bf16 v[160:175], v[108:111], v[132:135], v[160:175]
    s_setprio 0
    v_mul_f32 v100, v222, v239
    s_setprio 1
    v_mul_f32 v101, v224, v239
    v_mul_f32 v102, v226, v226
    v_mul_f32 v103, v228, v228
    v_cvt_pk_bf16_f32 v114, v100, v101
    v_cvt_pk_bf16_f32 v115, v102, v103
    s_waitcnt lgkmcnt(0)
    v_mfma_f32_32x32x16_bf16 v[144:159], v[104:107], v[120:123], v[144:159]
    s_setprio 0
    ds_read_b128 v[128:131], v215 offset:704
    ds_read_b128 v[132:135], v215 offset:736
    v_mul_f32 v96, v64, v80
    s_setprio 1
    v_mul_f32 v97, v66, v82
    v_mul_f32 v98, v64, v81
    v_mul_f32 v99, v66, v83
    v_cvt_pk_bf16_f32 v108, v96, v97
    v_cvt_pk_bf16_f32 v109, v98, v99
    v_mfma_f32_32x32x16_bf16 v[176:191], v[112:115], v[120:123], v[176:191]
    s_setprio 0
    s_cmp_eq_u32 s67, 7
    s_cbranch_scc0 L_site9
    buffer_load_dword v255, v251, s[40:43], s69 offen
L_site9:
    v_mul_f32 v100, v64, v82
    s_setprio 1
    v_mul_f32 v101, v66, v80
    v_mul_f32 v102, v64, v83
    v_mul_f32 v103, v66, v81
    v_cvt_pk_bf16_f32 v110, v100, v101
    v_cvt_pk_bf16_f32 v111, v102, v103
    v_mfma_f32_32x32x16_bf16 v[192:207], v[112:115], v[124:127], v[192:207]
    s_setprio 0
    v_mul_f32 v96, v90, v226
    s_setprio 1
    v_mul_f32 v97, v92, v228
    v_mul_f32 v98, v90, v227
    v_mul_f32 v99, v92, v229
    v_cvt_pk_bf16_f32 v116, v96, v97
    v_cvt_pk_bf16_f32 v117, v98, v99
    v_mfma_f32_32x32x16_bf16 v[160:175], v[104:107], v[124:127], v[160:175]
    s_setprio 0
    v_mul_f32 v100, v90, v228
    s_setprio 1
    v_mul_f32 v101, v92, v226
    v_mul_f32 v102, v90, v229
    v_mul_f32 v103, v92, v227
    v_cvt_pk_bf16_f32 v118, v100, v101
    v_cvt_pk_bf16_f32 v119, v102, v103
    s_waitcnt lgkmcnt(0)
    v_mfma_f32_32x32x16_bf16 v[144:159], v[108:111], v[128:131], v[144:159]
    s_setprio 0
    ds_read_b128 v[120:123], v215 offset:768
    ds_read_b128 v[124:127], v215 offset:800
    v_mul_f32 v96, v68, v80
    s_setprio 1
    v_mul_f32 v97, v70, v82
    v_mul_f32 v98, v68, v81
    v_mul_f32 v99, v70, v83
    v_cvt_pk_bf16_f32 v104, v96, v97
    v_cvt_pk_bf16_f32 v105, v98, v99
    v_mfma_f32_32x32x16_bf16 v[176:191], v[116:119], v[128:131], v[176:191]
    s_setprio 0
    v_mul_f32 v100, v68, v82
    s_setprio 1
    v_mul_f32 v101, v70, v80
    v_mul_f32 v102, v68, v83
    v_mul_f32 v103, v70, v81
    v_cvt_pk_bf16_f32 v106, v100, v101
    v_cvt_pk_bf16_f32 v107, v102, v103
    v_mfma_f32_32x32x16_bf16 v[192:207], v[116:119], v[132:135], v[192:207]
    s_setprio 0
    v_mul_f32 v96, v94, v226
    s_setprio 1
    v_mul_f32 v97, v216, v228
    v_mul_f32 v98, v94, v227
    v_mul_f32 v99, v216, v229
    v_cvt_pk_bf16_f32 v112, v96, v97
    v_cvt_pk_bf16_f32 v113, v98, v99
    v_mfma_f32_32x32x16_bf16 v[160:175], v[108:111], v[132:135], v[160:175]
    s_setprio 0
    v_mul_f32 v100, v94, v228
    s_setprio 1
    v_mul_f32 v101, v216, v226
    v_mul_f32 v102, v94, v229
    v_mul_f32 v103, v216, v227
    v_cvt_pk_bf16_f32 v114, v100, v101
    v_cvt_pk_bf16_f32 v115, v102, v103
    s_waitcnt lgkmcnt(0)
    v_mfma_f32_32x32x16_bf16 v[144:159], v[104:107], v[120:123], v[144:159]
    s_setprio 0
    ds_read_b128 v[128:131], v215 offset:832
    ds_read_b128 v[132:135], v215 offset:864
    v_mul_f32 v96, v72, v80
    s_setprio 1
    v_mul_f32 v97, v74, v82
    v_mul_f32 v98, v72, v81
    v_mul_f32 v99, v74, v83
    v_cvt_pk_bf16_f32 v108, v96, v97
    v_cvt_pk_bf16_f32 v109, v98, v99
    v_mfma_f32_32x32x16_bf16 v[176:191], v[112:115], v[120:123], v[176:191]
    s_setprio 0
    ds_read_u16_d16_hi v84, v212 offset:2560
    ds_read_u16_d16_hi v230, v212 offset:2624
    v_mul_f32 v100, v72, v82
    s_setprio 1
    v_mul_f32 v101, v74, v80
    v_mul_f32 v102, v72, v83
    v_mul_f32 v103, v74, v81
    v_cvt_pk_bf16_f32 v110, v100, v101
    v_cvt_pk_bf16_f32 v111, v102, v103
    v_mfma_f32_32x32x16_bf16 v[192:207], v[112:115], v[124:127], v[192:207]
    s_setprio 0
    v_mul_f32 v96, v218, v226
    s_setprio 1
    v_mul_f32 v97, v220, v228
    v_mul_f32 v98, v218, v227
    v_mul_f32 v99, v220, v229
    v_cvt_pk_bf16_f32 v116, v96, v97
    v_cvt_pk_bf16_f32 v117, v98, v99
    v_mfma_f32_32x32x16_bf16 v[160:175], v[104:107], v[124:127], v[160:175]
    s_setprio 0
    v_mul_f32 v100, v218, v228
    s_setprio 1
    v_mul_f32 v101, v220, v226
    v_mul_f32 v102, v218, v229
    v_mul_f32 v103, v220, v227
    v_cvt_pk_bf16_f32 v118, v100, v101
    v_cvt_pk_bf16_f32 v119, v102, v103
L_cl2:
    s_waitcnt lgkmcnt(2)
    v_mfma_f32_32x32x16_bf16 v[144:159], v[108:111], v[128:131], v[144:159]
    s_setprio 0
    ds_read_b128 v[120:123], v215 offset:896
    ds_read_b128 v[124:127], v215 offset:928
    v_mul_f32 v96, v76, v80
    s_setprio 1
    v_mul_f32 v97, v78, v82
    v_mul_f32 v98, v76, v81
    v_mul_f32 v99, v78, v83
    v_cvt_pk_bf16_f32 v104, v96, v97
    v_cvt_pk_bf16_f32 v105, v98, v99
    v_mfma_f32_32x32x16_bf16 v[176:191], v[116:119], v[128:131], v[176:191]
    s_setprio 0
    ds_read_u16_d16_hi v85, v212 offset:2688
    ds_read_u16_d16_hi v86, v212 offset:2816
    v_mul_f32 v100, v76, v82
    s_setprio 1
    v_mul_f32 v101, v78, v80
    v_mul_f32 v102, v76, v83
    v_mul_f32 v103, v78, v81
    v_cvt_pk_bf16_f32 v106, v100, v101
    v_cvt_pk_bf16_f32 v107, v102, v103
    v_mfma_f32_32x32x16_bf16 v[192:207], v[116:119], v[132:135], v[192:207]
    s_setprio 0
    ds_read_u16_d16_hi v87, v213 offset:2560
    ds_read_u16_d16_hi v231, v212 offset:2752
    v_mul_f32 v96, v222, v226
    s_setprio 1
    v_mul_f32 v97, v224, v228
    v_mul_f32 v98, v222, v227
    v_mul_f32 v99, v224, v229
    v_cvt_pk_bf16_f32 v112, v96, v97
    v_cvt_pk_bf16_f32 v113, v98, v99
    v_mfma_f32_32x32x16_bf16 v[160:175], v[108:111], v[132:135], v[160:175]
    s_setprio 0
    v_mul_f32 v100, v222, v228
    s_setprio 1
    v_mul_f32 v101, v224, v226
    v_mul_f32 v102, v222, v229
    v_mul_f32 v103, v224, v227
    v_cvt_pk_bf16_f32 v114, v100, v101
    v_cvt_pk_bf16_f32 v115, v102, v103
    s_waitcnt lgkmcnt(4)
    v_mfma_f32_32x32x16_bf16 v[144:159], v[104:107], v[120:123], v[144:159]
    s_setprio 0
    ds_read_b128 v[128:131], v215 offset:960
    ds_read_b128 v[132:135], v215 offset:992
    v_mul_f32 v96, v80, v81
    s_setprio 1
    v_mul_f32 v97, v82, v83
    v_mul_f32 v98, v80, v82
    v_mul_f32 v99, v80, v88
    v_cvt_pk_bf16_f32 v108, v96, v97
    v_cvt_pk_bf16_f32 v109, v98, v99
    v_mfma_f32_32x32x16_bf16 v[176:191], v[112:115], v[120:123], v[176:191]
    s_setprio 0
    ds_read_u16_d16_hi v236, v212 offset:2880
    ds_read_u16_d16_hi v237, v213 offset:2624
    v_mul_f32 v100, v82, v88
    s_setprio 1
    v_mul_f32 v101, v80, v89
    v_mul_f32 v102, v82, v89
    v_mul_f32 v103, v84, v84
    v_cvt_pk_bf16_f32 v110, v100, v101
    v_cvt_pk_bf16_f32 v111, v102, v103
    v_mfma_f32_32x32x16_bf16 v[192:207], v[112:115], v[124:127], v[192:207]
    s_setprio 0
    v_mul_f32 v96, v226, v227
    s_setprio 1
    v_mul_f32 v97, v228, v229
    v_mul_f32 v98, v226, v228
    v_mul_f32 v99, v226, v238
    v_cvt_pk_bf16_f32 v116, v96, v97
    v_cvt_pk_bf16_f32 v117, v98, v99
    v_mfma_f32_32x32x16_bf16 v[160:175], v[104:107], v[124:127], v[160:175]
    s_setprio 0
    v_mul_f32 v100, v228, v238
    s_setprio 1
    v_mul_f32 v101, v226, v239
    v_mul_f32 v102, v228, v239
    v_mul_f32 v103, v230, v230
    v_cvt_pk_bf16_f32 v118, v100, v101
    v_cvt_pk_bf16_f32 v119, v102, v103
    s_waitcnt lgkmcnt(0)
    v_mfma_f32_32x32x16_bf16 v[144:159], v[108:111], v[128:131], v[144:159]
    s_setprio 0
    ds_read_b128 v[120:123], v215 offset:1024
    ds_read_b128 v[124:127], v215 offset:1056
    v_mul_f32 v96, v86, v86
    s_setprio 1
    v_mul_f32 v97, v84, v85
    v_mul_f32 v98, v86, v87
    v_mul_f32 v99, v84, v86
    v_cvt_pk_bf16_f32 v104, v96, v97
    v_cvt_pk_bf16_f32 v105, v98, v99
    v_mfma_f32_32x32x16_bf16 v[176:191], v[116:119], v[128:131], v[176:191]
    s_setprio 0
    s_waitcnt vmcnt(0)
    buffer_load_dword v248, off, s[52:55], s31 sc1
    v_mul_f32 v100, v84, v88
    s_setprio 1
    v_mul_f32 v101, v86, v88
    v_mul_f32 v102, v84, v89
    v_mul_f32 v103, v86, v89
    v_cvt_pk_bf16_f32 v106, v100, v101
    v_cvt_pk_bf16_f32 v107, v102, v103
    v_mfma_f32_32x32x16_bf16 v[192:207], v[116:119], v[132:135], v[192:207]
    s_setprio 0
    v_mul_f32 v96, v236, v236
    s_setprio 1
    v_mul_f32 v97, v230, v231
    v_mul_f32 v98, v236, v237
    v_mul_f32 v99, v230, v236
    v_cvt_pk_bf16_f32 v112, v96, v97
    v_cvt_pk_bf16_f32 v113, v98, v99
    v_mfma_f32_32x32x16_bf16 v[160:175], v[108:111], v[132:135], v[160:175]
    s_setprio 0
    v_mul_f32 v100, v230, v238
    s_setprio 1
    v_mul_f32 v101, v236, v238
    v_mul_f32 v102, v230, v239
    v_mul_f32 v103, v236, v239
    v_cvt_pk_bf16_f32 v114, v100, v101
    v_cvt_pk_bf16_f32 v115, v102, v103
    s_waitcnt lgkmcnt(0)
    v_mfma_f32_32x32x16_bf16 v[144:159], v[104:107], v[120:123], v[144:159]
    s_setprio 0
    ds_read_b128 v[128:131], v215 offset:1088
    ds_read_b128 v[132:135], v215 offset:1120
    v_mul_f32 v96, v64, v84
    s_setprio 1
    v_mul_f32 v97, v66, v86
    v_mul_f32 v98, v64, v85
    v_mul_f32 v99, v66, v87
    v_cvt_pk_bf16_f32 v108, v96, v97
    v_cvt_pk_bf16_f32 v109, v98, v99
    v_mfma_f32_32x32x16_bf16 v[176:191], v[112:115], v[120:123], v[176:191]
    s_setprio 0
    v_mul_f32 v100, v64, v86
    s_setprio 1
    v_mul_f32 v101, v66, v84
    v_mul_f32 v102, v64, v87
    v_mul_f32 v103, v66, v85
    v_cvt_pk_bf16_f32 v110, v100, v101
    v_cvt_pk_bf16_f32 v111, v102, v103
    v_mfma_f32_32x32x16_bf16 v[192:207], v[112:115], v[124:127], v[192:207]
    s_setprio 0
    v_mul_f32 v96, v90, v230
    s_setprio 1
    v_mul_f32 v97, v92, v236
    v_mul_f32 v98, v90, v231
    v_mul_f32 v99, v92, v237
    v_cvt_pk_bf16_f32 v116, v96, v97
    v_cvt_pk_bf16_f32 v117, v98, v99
    v_mfma_f32_32x32x16_bf16 v[160:175], v[104:107], v[124:127], v[160:175]
    s_setprio 0
    v_mul_f32 v100, v90, v236
    s_setprio 1
    v_mul_f32 v101, v92, v230
    v_mul_f32 v102, v90, v237
    v_mul_f32 v103, v92, v231
    v_cvt_pk_bf16_f32 v118, v100, v101
    v_cvt_pk_bf16_f32 v119, v102, v103
    s_waitcnt lgkmcnt(0)
    v_mfma_f32_32x32x16_bf16 v[144:159], v[108:111], v[128:131], v[144:159]
    s_setprio 0
    ds_read_b128 v[120:123], v215 offset:1152
    ds_read_b128 v[124:127], v215 offset:1184
    v_mul_f32 v96, v68, v84
    s_setprio 1
    v_mul_f32 v97, v70, v86
    v_mul_f32 v98, v68, v85
    v_mul_f32 v99, v70, v87
    v_cvt_pk_bf16_f32 v104, v96, v97
    v_cvt_pk_bf16_f32 v105, v98, v99
    v_mfma_f32_32x32x16_bf16 v[176:191], v[116:119], v[128:131], v[176:191]
    s_setprio 0
    v_mul_f32 v100, v68, v86
    s_setprio 1
    v_mul_f32 v101, v70, v84
    v_mul_f32 v102, v68, v87
    v_mul_f32 v103, v70, v85
    v_cvt_pk_bf16_f32 v106, v100, v101
    v_cvt_pk_bf16_f32 v107, v102, v103
    v_mfma_f32_32x32x16_bf16 v[192:207], v[116:119], v[132:135], v[192:207]
    s_setprio 0
    ds_read_b64_tr_b16 v[16:17], v208 offset:0
    ds_read_b64_tr_b16 v[24:25], v208 offset:64
    v_mul_f32 v96, v94, v230
    s_setprio 1
    v_mul_f32 v97, v216, v236
    v_mul_f32 v98, v94, v231
    v_mul_f32 v99, v216, v237
    v_cvt_pk_bf16_f32 v112, v96, v97
    v_cvt_pk_bf16_f32 v113, v98, v99
    v_mfma_f32_32x32x16_bf16 v[160:175], v[108:111], v[132:135], v[160:175]
    s_setprio 0
    v_mul_f32 v100, v94, v236
    s_setprio 1
    v_mul_f32 v101, v216, v230
    v_mul_f32 v102, v94, v237
    v_mul_f32 v103, v216, v231
    v_cvt_pk_bf16_f32 v114, v100, v101
    v_cvt_pk_bf16_f32 v115, v102, v103
    s_waitcnt lgkmcnt(2)
    v_mfma_f32_32x32x16_bf16 v[144:159], v[104:107], v[120:123], v[144:159]
    s_setprio 0
    ds_read_b128 v[128:131], v215 offset:1216
    ds_read_b128 v[132:135], v215 offset:1248
    v_mul_f32 v96, v72, v84
    s_setprio 1
    v_mul_f32 v97, v74, v86
    v_mul_f32 v98, v72, v85
    v_mul_f32 v99, v74, v87
    v_cvt_pk_bf16_f32 v108, v96, v97
    v_cvt_pk_bf16_f32 v109, v98, v99
    v_mfma_f32_32x32x16_bf16 v[176:191], v[112:115], v[120:123], v[176:191]
    s_setprio 0
    v_mul_f32 v100, v72, v86
    s_setprio 1
    v_mul_f32 v101, v74, v84
    v_mul_f32 v102, v72, v87
    v_mul_f32 v103, v74, v85
    v_cvt_pk_bf16_f32 v110, v100, v101
    v_cvt_pk_bf16_f32 v111, v102, v103
    v_mfma_f32_32x32x16_bf16 v[192:207], v[112:115], v[124:127], v[192:207]
    s_setprio 0
    ds_read_b64_tr_b16 v[18:19], v209 offset:0
    ds_read_b64_tr_b16 v[26:27], v209 offset:64
    v_mul_f32 v96, v218, v230
    s_setprio 1
    v_mul_f32 v97, v220, v236
    v_mul_f32 v98, v218, v231
    v_mul_f32 v99, v220, v237
    v_cvt_pk_bf16_f32 v116, v96, v97
    v_cvt_pk_bf16_f32 v117, v98, v99
    v_mfma_f32_32x32x16_bf16 v[160:175], v[104:107], v[124:127], v[160:175]
    s_setprio 0
    v_mul_f32 v100, v218, v236
    s_setprio 1
    v_mul_f32 v101, v220, v230
    v_mul_f32 v102, v218, v237
    v_mul_f32 v103, v220, v231
    v_cvt_pk_bf16_f32 v118, v100, v101
    v_cvt_pk_bf16_f32 v119, v102, v103
    s_waitcnt lgkmcnt(2)
    v_mfma_f32_32x32x16_bf16 v[144:159], v[108:111], v[128:131], v[144:159]
    s_setprio 0
    ds_read_b128 v[120:123], v215 offset:1280
    ds_read_b128 v[124:127], v215 offset:1312
    v_mul_f32 v96, v76, v84
    s_setprio 1
    v_mul_f32 v97, v78, v86
    v_mul_f32 v98, v76, v85
    v_mul_f32 v99, v78, v87
    v_cvt_pk_bf16_f32 v104, v96, v97
    v_cvt_pk_bf16_f32 v105, v98, v99
    v_mfma_f32_32x32x16_bf16 v[176:191], v[116:119], v[128:131], v[176:191]
    s_setprio 0
    v_mul_f32 v100, v76, v86
    s_setprio 1
    v_mul_f32 v101, v78, v84
    v_mul_f32 v102, v76, v87
    v_mul_f32 v103, v78, v85
    v_cvt_pk_bf16_f32 v106, v100, v101
    v_cvt_pk_bf16_f32 v107, v102, v103
    v_mfma_f32_32x32x16_bf16 v[192:207], v[116:119], v[132:135], v[192:207]
    s_setprio 0
    ds_read_b64_tr_b16 v[20:21], v210 offset:0
    ds_read_b64_tr_b16 v[28:29], v210 offset:64
    v_mul_f32 v96, v222, v230
    s_setprio 1
    v_mul_f32 v97, v224, v236
    v_mul_f32 v98, v222, v231
    v_mul_f32 v99, v224, v237
    v_cvt_pk_bf16_f32 v112, v96, v97
    v_cvt_pk_bf16_f32 v113, v98, v99
    v_mfma_f32_32x32x16_bf16 v[160:175], v[108:111], v[132:135], v[160:175]
    s_setprio 0
    v_mul_f32 v100, v222, v236
    s_setprio 1
    v_mul_f32 v101, v224, v230
    v_mul_f32 v102, v222, v237
    v_mul_f32 v103, v224, v231
    v_cvt_pk_bf16_f32 v114, v100, v101
    v_cvt_pk_bf16_f32 v115, v102, v103
    s_waitcnt lgkmcnt(2)
    v_mfma_f32_32x32x16_bf16 v[144:159], v[104:107], v[120:123], v[144:159]
    s_setprio 0
    ds_read_b128 v[128:131], v215 offset:1344
    ds_read_b128 v[132:135], v215 offset:1376
    v_mul_f32 v96, v80, v84
    s_setprio 1
    v_mul_f32 v97, v82, v86
    v_mul_f32 v98, v80, v85
    v_mul_f32 v99, v82, v87
    v_cvt_pk_bf16_f32 v108, v96, v97
    v_cvt_pk_bf16_f32 v109, v98, v99
    v_mfma_f32_32x32x16_bf16 v[176:191], v[112:115], v[120:123], v[176:191]
    s_setprio 0
    v_mul_f32 v100, v80, v86
    s_setprio 1
    v_mul_f32 v101, v82, v84
    v_mul_f32 v102, v80, v87
    v_mul_f32 v103, v82, v85
    v_cvt_pk_bf16_f32 v110, v100, v101
    v_cvt_pk_bf16_f32 v111, v102, v103
    v_mfma_f32_32x32x16_bf16 v[192:207], v[112:115], v[124:127], v[192:207]
    s_setprio 0
    ds_read_b64_tr_b16 v[22:23], v211 offset:0
    ds_read_b64_tr_b16 v[30:31], v211 offset:64
    v_mul_f32 v96, v226, v230
    s_setprio 1
    v_mul_f32 v97, v228, v236
    v_mul_f32 v98, v226, v231
    v_mul_f32 v99, v228, v237
    v_cvt_pk_bf16_f32 v116, v96, v97
    v_cvt_pk_bf16_f32 v117, v98, v99
    v_mfma_f32_32x32x16_bf16 v[160:175], v[104:107], v[124:127], v[160:175]
    s_setprio 0
    v_mul_f32 v100, v226, v236
    s_setprio 1
    v_mul_f32 v101, v228, v230
    v_mul_f32 v102, v226, v237
    v_mul_f32 v103, v228, v231
    v_cvt_pk_bf16_f32 v118, v100, v101
    v_cvt_pk_bf16_f32 v119, v102, v103
    s_waitcnt lgkmcnt(2)
    v_mfma_f32_32x32x16_bf16 v[144:159], v[108:111], v[128:131], v[144:159]
    s_setprio 0
    ds_read_b128 v[136:139], v215 offset:1408
    ds_read_b128 v[140:143], v215 offset:1440
    ds_read_u16_d16_hi v64, v212 offset:26752
    ds_read_u16_d16_hi v65, v212 offset:26880
    ds_read_u16_d16_hi v66, v212 offset:27008
    v_mfma_f32_32x32x16_bf16 v[160:175], v[108:111], v[132:135], v[160:175]
    s_setprio 0
    ds_read_u16_d16_hi v67, v213 offset:26752
    ds_read_u16_d16_hi v88, v212 offset:29824
    ds_read_u16_d16_hi v89, v214 offset:29824
    ds_read_u16_d16_hi v90, v212 offset:26816
    ds_read_u16_d16_hi v91, v212 offset:26944
    v_mfma_f32_32x32x16_bf16 v[176:191], v[116:119], v[128:131], v[176:191]
    s_setprio 0
    ds_read_u16_d16_hi v92, v212 offset:27072
    ds_read_u16_d16_hi v93, v213 offset:26816
    ds_read_u16_d16_hi v238, v212 offset:29888
    ds_read_u16_d16_hi v239, v214 offset:29888
    s_waitcnt vmcnt(0)
    v_readfirstlane_b32 s64, v248
    s_cmp_lt_u32 s64, 4
    s_cbranch_scc1 L_notyet
    s_mov_b32 s101, 1
    buffer_load_dword v249, v244, s[44:47], 0 offen sc1
L_notyet:
    s_waitcnt lgkmcnt(6)
    v_mfma_f32_32x32x16_bf16 v[192:207], v[116:119], v[132:135], v[192:207]
    s_setprio 0
    ds_read_u16_d16_hi v68, v212 offset:27264
    ds_read_u16_d16_hi v69, v212 offset:27392
    v_mul_f32 v96, v88, v88
    s_setprio 1
    v_mul_f32 v97, v88, v89
    v_mul_f32 v98, v64, v64
    v_mul_f32 v99, v66, v66
    v_cvt_pk_bf16_f32 v104, v96, v97
    v_cvt_pk_bf16_f32 v105, v98, v99
    v_mfma_f32_32x32x16_bf16 v[160:175], v[16:19], v[136:139], v[160:175]
    s_setprio 0
    ds_read_b128 v[120:123], v215 offset:0
    ds_read_b128 v[124:127], v215 offset:32
    v_mul_f32 v100, v64, v65
    s_setprio 1
    v_mul_f32 v101, v66, v67
    v_mul_f32 v102, v64, v66
    v_mul_f32 v103, v64, v88
    v_cvt_pk_bf16_f32 v106, v100, v101
    v_cvt_pk_bf16_f32 v107, v102, v103
    s_waitcnt lgkmcnt(4)
    v_mfma_f32_32x32x16_bf16 v[160:175], v[20:23], v[140:143], v[160:175]
    s_setprio 0
    ds_read_u16_d16_hi v70, v212 offset:27520
    ds_read_u16_d16_hi v71, v213 offset:27264
    ds_read_u16_d16_hi v94, v212 offset:27328
    v_mul_f32 v96, v238, v238
    s_setprio 1
    v_mul_f32 v97, v238, v239
    v_mul_f32 v98, v90, v90
    v_mul_f32 v99, v92, v92
    v_cvt_pk_bf16_f32 v112, v96, v97
    v_cvt_pk_bf16_f32 v113, v98, v99
    v_mfma_f32_32x32x16_bf16 v[192:207], v[24:27], v[136:139], v[192:207]
    s_setprio 0
    ds_read_u16_d16_hi v95, v212 offset:27456
    ds_read_u16_d16_hi v216, v212 offset:27584
    ds_read_u16_d16_hi v217, v213 offset:27328
    v_mul_f32 v100, v90, v91
    s_setprio 1
    v_mul_f32 v101, v92, v93
    v_mul_f32 v102, v90, v92
    v_mul_f32 v103, v90, v238
    v_cvt_pk_bf16_f32 v114, v100, v101
    v_cvt_pk_bf16_f32 v115, v102, v103
    v_mfma_f32_32x32x16_bf16 v[192:207], v[28:31], v[140:143], v[192:207]
    s_setprio 0
    v_mov_b32 v240, v242
    s_setprio 1
    v_mul_f32 v32, v144, v160
    v_mul_f32 v33, v145, v161
    v_fmac_f32 v32, v146, v162
    v_fmac_f32 v33, v147, v163
    v_fmac_f32 v32, v148, v164
    v_fmac_f32 v33, v149, v165
    v_fmac_f32 v32, v150, v166
    v_fmac_f32 v33, v151, v167
    v_fmac_f32 v32, v152, v168
    v_fmac_f32 v33, v153, v169
    v_fmac_f32 v32, v154, v170
    v_fmac_f32 v33, v155, v171
    v_fmac_f32 v32, v156, v172
    v_fmac_f32 v33, v157, v173
    v_fmac_f32 v32, v158, v174
    v_fmac_f32 v33, v159, v175
    v_add_f32 v32, v32, v33
    v_cndmask_b32 v242, 0, v32, vcc
    v_add_u32 v208, 26752, v208
    v_add_u32 v209, 26752, v209
    v_add_u32 v210, 26752, v210
    v_add_u32 v211, 26752, v211
    v_add_u32 v212, 26752, v212
    v_add_u32 v213, 26752, v213
    v_add_u32 v214, 26752, v214
    s_cmp_eq_u32 s67, 99
    s_mov_b32 s67, 99
    s_waitcnt lgkmcnt(0)
    s_cbranch_scc0 L_cloop
L_cfin:
    s_setprio 0
    v_mul_f32 v36, v176, v192
    v_mul_f32 v37, v177, v193
    v_fmac_f32 v36, v178, v194
    v_fmac_f32 v37, v179, v195
    v_fmac_f32 v36, v180, v196
    v_fmac_f32 v37, v181, v197
    v_fmac_f32 v36, v182, v198
    v_fmac_f32 v37, v183, v199
    v_fmac_f32 v36, v184, v200
    v_fmac_f32 v37, v185, v201
    v_fmac_f32 v36, v186, v202
    v_fmac_f32 v37, v187, v203
    v_fmac_f32 v36, v188, v204
    v_fmac_f32 v37, v189, v205
    v_fmac_f32 v36, v190, v206
    v_fmac_f32 v37, v191, v207
    v_add_f32 v36, v36, v37
    v_cndmask_b32 v243, 0, v36, vcc
    v_permlane32_swap_b32 v240, v241
    s_cmp_eq_u32 s101, 1
    s_cbranch_scc1 L_cok
    s_mov_b32 s65, 0x20000
L_cspin:
    buffer_load_dword v248, off, s[52:55], s31 sc1
    s_waitcnt vmcnt(0)
    v_readfirstlane_b32 s64, v248
    s_sub_u32 s65, s65, 1
    s_cbranch_scc1 L_cgo
    s_cmp_lt_u32 s64, 4
    s_cbranch_scc1 L_cspin
L_cgo:
    buffer_load_dword v249, v244, s[44:47], 0 offen sc1
L_cok:
    v_permlane32_swap_b32 v242, v243
    v_add_f32 v240, v240, v241
    v_add_f32 v242, v242, v243
    s_mov_b32 s65, 0x20000
    s_nop 0
    v_permlane16_swap_b32 v240, v242
    v_add_f32 v240, v240, v242
L_pspin:
    s_waitcnt vmcnt(0)
    v_cmp_eq_u32 vcc, -1, v249
    s_cbranch_vccz L_pok
    s_sub_u32 s65, s65, 1
    s_cbranch_scc1 L_pok
    buffer_load_dword v249, v244, s[44:47], 0 offen sc1
    s_branch L_pspin
L_pok:
    v_add_f32 v240, v240, v249
    s_nop 1
    v_add_f32_dpp v240, v240, v240 row_ror:8 row_mask:0xf bank_mask:0xf
    s_nop 1
    v_add_f32_dpp v240, v240, v240 row_ror:4 row_mask:0xf bank_mask:0xf
    s_nop 1
    v_add_f32_dpp v240, v240, v240 row_ror:2 row_mask:0xf bank_mask:0xf
    s_nop 1
    v_add_f32_dpp v240, v240, v240 row_ror:1 row_mask:0xf bank_mask:0xf
    v_add_f32 v240, v240, v247
    v_cvt_pk_bf16_f32 v240, v240, v240
    buffer_store_short v240, v246, s[56:59], 0 offen
    s_endpgm
L_loader:
    s_mov_b32 s36, s6
    s_mov_b32 s37, s7
    s_mov_b32 s38, 6400000
    s_mov_b32 s39, 0x20000
    s_mul_i32 s65, s30, 416
    s_mul_i32 s64, s66, 192
    s_add_u32 s64, s64, 0
    v_add_u32 v2, s64, v0
    v_mul_u32_u24 v3, 2521, v2
    v_lshrrev_b32 v3, 16, v3
    v_mul_u32_u24 v4, 26, v3
    v_sub_u32 v4, v2, v4
    v_lshrrev_b32 v5, 1, v3
    v_xor_b32 v5, v5, v3
    v_bfe_u32 v5, v5, 2, 1
    v_mul_u32_u24 v5, 12, v5
    v_xor_b32 v3, v3, v5
    v_mul_u32_u24 v3, 1664, v3
    v_lshl_add_u32 v3, v4, 4, v3
    v_add_u32 v10, s65, v3
    s_mul_i32 s64, s66, 192
    s_add_u32 s64, s64, 64
    v_add_u32 v2, s64, v0
    v_mul_u32_u24 v3, 2521, v2
    v_lshrrev_b32 v3, 16, v3
    v_mul_u32_u24 v4, 26, v3
    v_sub_u32 v4, v2, v4
    v_lshrrev_b32 v5, 1, v3
    v_xor_b32 v5, v5, v3
    v_bfe_u32 v5, v5, 2, 1
    v_mul_u32_u24 v5, 12, v5
    v_xor_b32 v3, v3, v5
    v_mul_u32_u24 v3, 1664, v3
    v_lshl_add_u32 v3, v4, 4, v3
    v_add_u32 v11, s65, v3
    s_mul_i32 s64, s66, 192
    s_add_u32 s64, s64, 128
    v_add_u32 v2, s64, v0
    v_mul_u32_u24 v3, 2521, v2
    v_lshrrev_b32 v3, 16, v3
    v_mul_u32_u24 v4, 26, v3
    v_sub_u32 v4, v2, v4
    v_lshrrev_b32 v5, 1, v3
    v_xor_b32 v5, v5, v3
    v_bfe_u32 v5, v5, 2, 1
    v_mul_u32_u24 v5, 12, v5
    v_xor_b32 v3, v3, v5
    v_mul_u32_u24 v3, 1664, v3
    v_lshl_add_u32 v3, v4, 4, v3
    v_add_u32 v12, s65, v3
    s_mov_b32 s64, 768
    v_add_u32 v2, s64, v0
    v_mul_u32_u24 v3, 2521, v2
    v_lshrrev_b32 v3, 16, v3
    v_mul_u32_u24 v4, 26, v3
    v_sub_u32 v4, v2, v4
    v_lshrrev_b32 v5, 1, v3
    v_xor_b32 v5, v5, v3
    v_bfe_u32 v5, v5, 2, 1
    v_mul_u32_u24 v5, 12, v5
    v_xor_b32 v3, v3, v5
    v_mul_u32_u24 v3, 1664, v3
    v_lshl_add_u32 v3, v4, 4, v3
    v_add_u32 v9, s65, v3
    s_cmp_ge_u32 s66, 3
    s_cbranch_scc1 L_wl
    buffer_load_dword v35, v251, s[40:43], s60 offen
L_wl:
    s_mov_b32 s44, s24
    s_mov_b32 s45, s25
    s_mov_b32 s46, 131072
    s_mov_b32 s47, 0x20000
    s_mov_b32 s52, s22
    s_mov_b32 s53, s23
    s_mov_b32 s54, 256
    s_mov_b32 s55, 0x20000
    s_lshl_b32 s64, s29, 12
    s_lshl_b32 s65, s30, 10
    s_add_u32 s64, s64, s65
    s_lshl_b32 s65, s66, 8
    s_add_u32 s64, s64, s65
    s_add_u32 s64, s64, 0
    v_lshl_add_u32 v31, v0, 2, s64
    v_mov_b32 v30, -1
    v_mov_b32 v32, 1
    s_mul_i32 s62, s66, 3072
    s_add_u32 s62, s62, 8192
    s_lshl_b32 s63, s66, 11
    v_lshrrev_b32 v2, 2, v0
    v_mul_u32_u24 v2, 104, v2
    s_mul_i32 s68, s30, 0
    s_mul_i32 s69, s68, 53248
    s_lshl_b32 s64, s68, 2
    s_add_u32 s64, s64, s67
    v_add_u32 v14, s64, v2
    v_and_b32 v2, 3, v0
    v_bfe_u32 v3, v0, 4, 1
    v_lshlrev_b32 v3, 1, v3
    v_xor_b32 v2, v2, v3
    v_lshlrev_b32 v13, 4, v2
    v_and_b32 v2, 7, v0
    s_lshl_b32 s64, s30, 3
    v_add_u32 v2, s64, v2
    v_mul_u32_u24 v2, 104, v2
    v_lshrrev_b32 v3, 3, v0
    v_lshl_add_u32 v2, v3, 2, v2
    s_add_u32 s64, s67, 0
    v_add_u32 v36, s64, v2
    v_cmp_gt_u32 vcc, 4, v3
    v_mov_b32 v38, 2146435072
    s_waitcnt vmcnt(1)
    ds_read_b32 v64, v14 offset:0
    ds_read_b32 v65, v14 offset:1664
    ds_read_b32 v66, v14 offset:4
    ds_read_b32 v67, v14 offset:1668
    ds_read_b32 v68, v14 offset:8
    ds_read_b32 v69, v14 offset:1672
    ds_read_b32 v36, v36
    s_waitcnt lgkmcnt(0)
    v_lshlrev_b32 v36, 6, v36
    v_cndmask_b32 v36, v38, v36, vcc
    buffer_load_dword v37, v36, s[36:39], 0 offen
    s_waitcnt lgkmcnt(5)
    s_add_u32 m0, s63, 0
    v_lshl_add_u32 v64, v64, 6, v13
    buffer_load_dwordx4 v64, s[36:39], 0 offen lds
    s_add_u32 m0, s63, 1024
    v_lshl_add_u32 v65, v65, 6, v13
    buffer_load_dwordx4 v65, s[36:39], 0 offen lds
    ds_read_b32 v70, v14 offset:12
    ds_read_b32 v71, v14 offset:1676
    ds_read_b32 v72, v14 offset:16
    ds_read_b32 v73, v14 offset:1680
    ds_read_b32 v74, v14 offset:20
    ds_read_b32 v75, v14 offset:1684
    ds_read_b32 v76, v14 offset:24
    ds_read_b32 v77, v14 offset:1688
    ds_read_b32 v78, v14 offset:28
    ds_read_b32 v79, v14 offset:1692
    ds_read_b32 v80, v14 offset:32
    ds_read_b32 v81, v14 offset:1696
    ds_read_b32 v82, v14 offset:36
    ds_read_b32 v83, v14 offset:1700
    ds_read_b32 v84, v14 offset:40
    ds_read_b32 v85, v14 offset:1704
    ds_read_b32 v86, v14 offset:44
    ds_read_b32 v87, v14 offset:1708
    ds_read_b32 v88, v14 offset:48
    ds_read_b32 v89, v14 offset:1712
    ds_read_b32 v90, v14 offset:52
    ds_read_b32 v91, v14 offset:1716
    ds_read_b32 v92, v14 offset:56
    ds_read_b32 v93, v14 offset:1720
    ds_read_b32 v94, v14 offset:60
    ds_read_b32 v95, v14 offset:1724
    ds_read_b32 v96, v14 offset:64
    ds_read_b32 v97, v14 offset:1728
    ds_read_b32 v98, v14 offset:68
    ds_read_b32 v99, v14 offset:1732
    ds_read_b32 v100, v14 offset:72
    ds_read_b32 v101, v14 offset:1736
    ds_read_b32 v102, v14 offset:76
    ds_read_b32 v103, v14 offset:1740
    ds_read_b32 v104, v14 offset:80
    ds_read_b32 v105, v14 offset:1744
    ds_read_b32 v106, v14 offset:84
    ds_read_b32 v107, v14 offset:1748
    ds_read_b32 v108, v14 offset:88
    ds_read_b32 v109, v14 offset:1752
    ds_read_b32 v110, v14 offset:92
    ds_read_b32 v111, v14 offset:1756
    ds_read_b32 v112, v14 offset:96
    ds_read_b32 v113, v14 offset:1760
    ds_read_b32 v114, v14 offset:100
    ds_read_b32 v115, v14 offset:1764
    s_waitcnt lgkmcnt(15)
    v_lshl_add_u32 v70, v70, 6, v13
    v_lshl_add_u32 v71, v71, 6, v13
    v_lshl_add_u32 v72, v72, 6, v13
    v_lshl_add_u32 v73, v73, 6, v13
    v_lshl_add_u32 v74, v74, 6, v13
    v_lshl_add_u32 v75, v75, 6, v13
    v_lshl_add_u32 v76, v76, 6, v13
    v_lshl_add_u32 v77, v77, 6, v13
    s_waitcnt lgkmcnt(15)
    v_lshl_add_u32 v78, v78, 6, v13
    v_lshl_add_u32 v79, v79, 6, v13
    v_lshl_add_u32 v80, v80, 6, v13
    v_lshl_add_u32 v81, v81, 6, v13
    v_lshl_add_u32 v82, v82, 6, v13
    v_lshl_add_u32 v83, v83, 6, v13
    v_lshl_add_u32 v84, v84, 6, v13
    v_lshl_add_u32 v85, v85, 6, v13
    s_waitcnt lgkmcnt(15)
    v_lshl_add_u32 v86, v86, 6, v13
    v_lshl_add_u32 v87, v87, 6, v13
    v_lshl_add_u32 v88, v88, 6, v13
    v_lshl_add_u32 v89, v89, 6, v13
    v_lshl_add_u32 v90, v90, 6, v13
    v_lshl_add_u32 v91, v91, 6, v13
    v_lshl_add_u32 v92, v92, 6, v13
    v_lshl_add_u32 v93, v93, 6, v13
    s_waitcnt lgkmcnt(14)
    v_lshl_add_u32 v94, v94, 6, v13
    v_lshl_add_u32 v95, v95, 6, v13
    v_lshl_add_u32 v96, v96, 6, v13
    v_lshl_add_u32 v97, v97, 6, v13
    v_lshl_add_u32 v98, v98, 6, v13
    v_lshl_add_u32 v99, v99, 6, v13
    v_lshl_add_u32 v100, v100, 6, v13
    v_lshl_add_u32 v101, v101, 6, v13
    s_waitcnt lgkmcnt(6)
    v_lshl_add_u32 v102, v102, 6, v13
    v_lshl_add_u32 v103, v103, 6, v13
    v_lshl_add_u32 v104, v104, 6, v13
    v_lshl_add_u32 v105, v105, 6, v13
    v_lshl_add_u32 v106, v106, 6, v13
    v_lshl_add_u32 v107, v107, 6, v13
    v_lshl_add_u32 v108, v108, 6, v13
    v_lshl_add_u32 v109, v109, 6, v13
    s_waitcnt lgkmcnt(0)
    v_lshl_add_u32 v110, v110, 6, v13
    v_lshl_add_u32 v111, v111, 6, v13
    v_lshl_add_u32 v112, v112, 6, v13
    v_lshl_add_u32 v113, v113, 6, v13
    v_lshl_add_u32 v114, v114, 6, v13
    v_lshl_add_u32 v115, v115, 6, v13
    s_cmp_lg_u32 s66, 0
    s_cbranch_scc1 L_q0
    s_mov_b32 m0, 20480
    s_nop 0
    buffer_load_dwordx4 v9, s[40:43], s69 offen lds
L_q0:
    s_add_u32 m0, s62, 0
    s_nop 0
    buffer_load_dwordx4 v10, s[40:43], s69 offen lds
    s_add_u32 m0, s62, 1024
    s_nop 0
    buffer_load_dwordx4 v11, s[40:43], s69 offen lds
    s_add_u32 m0, s62, 2048
    s_nop 0
    buffer_load_dwordx4 v12, s[40:43], s69 offen lds
    s_add_u32 s69, s69, 53248
    s_add_u32 m0, s63, 21504
    v_lshl_add_u32 v66, v66, 6, v13
    buffer_load_dwordx4 v66, s[36:39], 0 offen lds
    s_add_u32 m0, s63, 22528
    v_lshl_add_u32 v67, v67, 6, v13
    buffer_load_dwordx4 v67, s[36:39], 0 offen lds
    s_cmp_lg_u32 s66, 1
    s_cbranch_scc1 L_q1
    s_mov_b32 m0, 41984
    s_nop 0
    buffer_load_dwordx4 v9, s[40:43], s69 offen lds
L_q1:
    s_add_u32 m0, s62, 21504
    s_nop 0
    buffer_load_dwordx4 v10, s[40:43], s69 offen lds
    s_add_u32 m0, s62, 22528
    s_nop 0
    buffer_load_dwordx4 v11, s[40:43], s69 offen lds
    s_add_u32 m0, s62, 23552
    s_nop 0
    buffer_load_dwordx4 v12, s[40:43], s69 offen lds
    s_add_u32 s69, s69, 53248
    s_add_u32 m0, s63, 43008
    v_lshl_add_u32 v68, v68, 6, v13
    buffer_load_dwordx4 v68, s[36:39], 0 offen lds
    s_add_u32 m0, s63, 44032
    v_lshl_add_u32 v69, v69, 6, v13
    buffer_load_dwordx4 v69, s[36:39], 0 offen lds
    s_cmp_lg_u32 s66, 2
    s_cbranch_scc1 L_q2
    s_mov_b32 m0, 63488
    s_nop 0
    buffer_load_dwordx4 v9, s[40:43], s69 offen lds
L_q2:
    s_add_u32 m0, s62, 43008
    s_nop 0
    buffer_load_dwordx4 v10, s[40:43], s69 offen lds
    s_add_u32 m0, s62, 44032
    s_nop 0
    buffer_load_dwordx4 v11, s[40:43], s69 offen lds
    s_add_u32 m0, s62, 45056
    s_nop 0
    buffer_load_dwordx4 v12, s[40:43], s69 offen lds
    s_add_u32 s69, s69, 53248
    s_waitcnt vmcnt(10)
    s_barrier
    s_add_u32 m0, s63, 64512
    s_nop 0
    buffer_load_dwordx4 v70, s[36:39], 0 offen lds
    s_add_u32 m0, s63, 65536
    s_nop 0
    buffer_load_dwordx4 v71, s[36:39], 0 offen lds
    s_cmp_lg_u32 s66, 3
    s_cbranch_scc1 L_q3
    s_mov_b32 m0, 84992
    s_nop 0
    buffer_load_dwordx4 v9, s[40:43], s69 offen lds
L_q3:
    s_add_u32 m0, s62, 64512
    s_nop 0
    buffer_load_dwordx4 v10, s[40:43], s69 offen lds
    s_add_u32 m0, s62, 65536
    s_nop 0
    buffer_load_dwordx4 v11, s[40:43], s69 offen lds
    s_add_u32 m0, s62, 66560
    s_nop 0
    buffer_load_dwordx4 v12, s[40:43], s69 offen lds
    s_add_u32 s69, s69, 53248
    s_waitcnt vmcnt(10)
    s_barrier
    s_add_u32 m0, s63, 86016
    s_nop 0
    buffer_load_dwordx4 v72, s[36:39], 0 offen lds
    s_add_u32 m0, s63, 87040
    s_nop 0
    buffer_load_dwordx4 v73, s[36:39], 0 offen lds
    s_cmp_lg_u32 s66, 0
    s_cbranch_scc1 L_q4
    s_mov_b32 m0, 106496
    s_nop 0
    buffer_load_dwordx4 v9, s[40:43], s69 offen lds
L_q4:
    s_add_u32 m0, s62, 86016
    s_nop 0
    buffer_load_dwordx4 v10, s[40:43], s69 offen lds
    s_add_u32 m0, s62, 87040
    s_nop 0
    buffer_load_dwordx4 v11, s[40:43], s69 offen lds
    s_add_u32 m0, s62, 88064
    s_nop 0
    buffer_load_dwordx4 v12, s[40:43], s69 offen lds
    s_add_u32 s69, s69, 53248
    s_waitcnt vmcnt(10)
    s_barrier
    s_add_u32 m0, s63, 107520
    s_nop 0
    buffer_load_dwordx4 v74, s[36:39], 0 offen lds
    s_add_u32 m0, s63, 108544
    s_nop 0
    buffer_load_dwordx4 v75, s[36:39], 0 offen lds
    s_cmp_lg_u32 s66, 1
    s_cbranch_scc1 L_q5
    s_mov_b32 m0, 128000
    s_nop 0
    buffer_load_dwordx4 v9, s[40:43], s69 offen lds
L_q5:
    s_add_u32 m0, s62, 107520
    s_nop 0
    buffer_load_dwordx4 v10, s[40:43], s69 offen lds
    s_add_u32 m0, s62, 108544
    s_nop 0
    buffer_load_dwordx4 v11, s[40:43], s69 offen lds
    s_add_u32 m0, s62, 109568
    s_nop 0
    buffer_load_dwordx4 v12, s[40:43], s69 offen lds
    s_add_u32 s69, s69, 53248
    s_waitcnt vmcnt(10)
    s_barrier
    s_add_u32 m0, s63, 0
    s_nop 0
    buffer_load_dwordx4 v76, s[36:39], 0 offen lds
    s_add_u32 m0, s63, 1024
    s_nop 0
    buffer_load_dwordx4 v77, s[36:39], 0 offen lds
    s_cmp_lg_u32 s66, 2
    s_cbranch_scc1 L_q6
    s_mov_b32 m0, 20480
    s_nop 0
    buffer_load_dwordx4 v9, s[40:43], s69 offen lds
L_q6:
    s_add_u32 m0, s62, 0
    s_nop 0
    buffer_load_dwordx4 v10, s[40:43], s69 offen lds
    s_add_u32 m0, s62, 1024
    s_nop 0
    buffer_load_dwordx4 v11, s[40:43], s69 offen lds
    s_add_u32 m0, s62, 2048
    s_nop 0
    buffer_load_dwordx4 v12, s[40:43], s69 offen lds
    s_add_u32 s69, s69, 53248
    s_waitcnt vmcnt(10)
    s_barrier
    s_add_u32 m0, s63, 21504
    s_nop 0
    buffer_load_dwordx4 v78, s[36:39], 0 offen lds
    s_add_u32 m0, s63, 22528
    s_nop 0
    buffer_load_dwordx4 v79, s[36:39], 0 offen lds
    s_cmp_lg_u32 s66, 3
    s_cbranch_scc1 L_q7
    s_mov_b32 m0, 41984
    s_nop 0
    buffer_load_dwordx4 v9, s[40:43], s69 offen lds
L_q7:
    s_add_u32 m0, s62, 21504
    s_nop 0
    buffer_load_dwordx4 v10, s[40:43], s69 offen lds
    s_add_u32 m0, s62, 22528
    s_nop 0
    buffer_load_dwordx4 v11, s[40:43], s69 offen lds
    s_add_u32 m0, s62, 23552
    s_nop 0
    buffer_load_dwordx4 v12, s[40:43], s69 offen lds
    s_add_u32 s69, s69, 53248
    s_waitcnt vmcnt(10)
    s_barrier
    s_add_u32 m0, s63, 43008
    s_nop 0
    buffer_load_dwordx4 v80, s[36:39], 0 offen lds
    s_add_u32 m0, s63, 44032
    s_nop 0
    buffer_load_dwordx4 v81, s[36:39], 0 offen lds
    s_cmp_lg_u32 s66, 0
    s_cbranch_scc1 L_q8
    s_mov_b32 m0, 63488
    s_nop 0
    buffer_load_dwordx4 v9, s[40:43], s69 offen lds
L_q8:
    s_add_u32 m0, s62, 43008
    s_nop 0
    buffer_load_dwordx4 v10, s[40:43], s69 offen lds
    s_add_u32 m0, s62, 44032
    s_nop 0
    buffer_load_dwordx4 v11, s[40:43], s69 offen lds
    s_add_u32 m0, s62, 45056
    s_nop 0
    buffer_load_dwordx4 v12, s[40:43], s69 offen lds
    s_add_u32 s69, s69, 53248
    s_waitcnt vmcnt(10)
    s_barrier
    s_add_u32 m0, s63, 64512
    s_nop 0
    buffer_load_dwordx4 v82, s[36:39], 0 offen lds
    s_add_u32 m0, s63, 65536
    s_nop 0
    buffer_load_dwordx4 v83, s[36:39], 0 offen lds
    s_cmp_lg_u32 s66, 1
    s_cbranch_scc1 L_q9
    s_mov_b32 m0, 84992
    s_nop 0
    buffer_load_dwordx4 v9, s[40:43], s69 offen lds
L_q9:
    s_add_u32 m0, s62, 64512
    s_nop 0
    buffer_load_dwordx4 v10, s[40:43], s69 offen lds
    s_add_u32 m0, s62, 65536
    s_nop 0
    buffer_load_dwordx4 v11, s[40:43], s69 offen lds
    s_add_u32 m0, s62, 66560
    s_nop 0
    buffer_load_dwordx4 v12, s[40:43], s69 offen lds
    s_add_u32 s69, s69, 53248
    s_waitcnt vmcnt(10)
    s_barrier
    s_add_u32 m0, s63, 86016
    s_nop 0
    buffer_load_dwordx4 v84, s[36:39], 0 offen lds
    s_add_u32 m0, s63, 87040
    s_nop 0
    buffer_load_dwordx4 v85, s[36:39], 0 offen lds
    s_cmp_lg_u32 s66, 2
    s_cbranch_scc1 L_q10
    s_mov_b32 m0, 106496
    s_nop 0
    buffer_load_dwordx4 v9, s[40:43], s69 offen lds
L_q10:
    s_add_u32 m0, s62, 86016
    s_nop 0
    buffer_load_dwordx4 v10, s[40:43], s69 offen lds
    s_add_u32 m0, s62, 87040
    s_nop 0
    buffer_load_dwordx4 v11, s[40:43], s69 offen lds
    s_add_u32 m0, s62, 88064
    s_nop 0
    buffer_load_dwordx4 v12, s[40:43], s69 offen lds
    s_add_u32 s69, s69, 53248
    s_waitcnt vmcnt(10)
    s_barrier
    s_add_u32 m0, s63, 107520
    s_nop 0
    buffer_load_dwordx4 v86, s[36:39], 0 offen lds
    s_add_u32 m0, s63, 108544
    s_nop 0
    buffer_load_dwordx4 v87, s[36:39], 0 offen lds
    s_cmp_lg_u32 s66, 3
    s_cbranch_scc1 L_q11
    s_mov_b32 m0, 128000
    s_nop 0
    buffer_load_dwordx4 v9, s[40:43], s69 offen lds
L_q11:
    s_add_u32 m0, s62, 107520
    s_nop 0
    buffer_load_dwordx4 v10, s[40:43], s69 offen lds
    s_add_u32 m0, s62, 108544
    s_nop 0
    buffer_load_dwordx4 v11, s[40:43], s69 offen lds
    s_add_u32 m0, s62, 109568
    s_nop 0
    buffer_load_dwordx4 v12, s[40:43], s69 offen lds
    s_add_u32 s69, s69, 53248
    s_waitcnt vmcnt(10)
    s_barrier
    s_add_u32 m0, s63, 0
    s_nop 0
    buffer_load_dwordx4 v88, s[36:39], 0 offen lds
    s_add_u32 m0, s63, 1024
    s_nop 0
    buffer_load_dwordx4 v89, s[36:39], 0 offen lds
    s_cmp_lg_u32 s66, 0
    s_cbranch_scc1 L_q12
    s_mov_b32 m0, 20480
    s_nop 0
    buffer_load_dwordx4 v9, s[40:43], s69 offen lds
L_q12:
    s_add_u32 m0, s62, 0
    s_nop 0
    buffer_load_dwordx4 v10, s[40:43], s69 offen lds
    s_add_u32 m0, s62, 1024
    s_nop 0
    buffer_load_dwordx4 v11, s[40:43], s69 offen lds
    s_add_u32 m0, s62, 2048
    s_nop 0
    buffer_load_dwordx4 v12, s[40:43], s69 offen lds
    s_add_u32 s69, s69, 53248
    buffer_store_dword v30, v31, s[44:47], 0 offen sc1
    s_waitcnt vmcnt(11)
    s_barrier
    s_add_u32 m0, s63, 21504
    s_nop 0
    buffer_load_dwordx4 v90, s[36:39], 0 offen lds
    s_add_u32 m0, s63, 22528
    s_nop 0
    buffer_load_dwordx4 v91, s[36:39], 0 offen lds
    s_cmp_lg_u32 s66, 1
    s_cbranch_scc1 L_q13
    s_mov_b32 m0, 41984
    s_nop 0
    buffer_load_dwordx4 v9, s[40:43], s69 offen lds
L_q13:
    s_add_u32 m0, s62, 21504
    s_nop 0
    buffer_load_dwordx4 v10, s[40:43], s69 offen lds
    s_add_u32 m0, s62, 22528
    s_nop 0
    buffer_load_dwordx4 v11, s[40:43], s69 offen lds
    s_add_u32 m0, s62, 23552
    s_nop 0
    buffer_load_dwordx4 v12, s[40:43], s69 offen lds
    s_add_u32 s69, s69, 53248
    s_waitcnt vmcnt(11)
    s_barrier
    s_add_u32 m0, s63, 43008
    s_nop 0
    buffer_load_dwordx4 v92, s[36:39], 0 offen lds
    s_add_u32 m0, s63, 44032
    s_nop 0
    buffer_load_dwordx4 v93, s[36:39], 0 offen lds
    s_cmp_lg_u32 s66, 2
    s_cbranch_scc1 L_q14
    s_mov_b32 m0, 63488
    s_nop 0
    buffer_load_dwordx4 v9, s[40:43], s69 offen lds
L_q14:
    s_add_u32 m0, s62, 43008
    s_nop 0
    buffer_load_dwordx4 v10, s[40:43], s69 offen lds
    s_add_u32 m0, s62, 44032
    s_nop 0
    buffer_load_dwordx4 v11, s[40:43], s69 offen lds
    s_add_u32 m0, s62, 45056
    s_nop 0
    buffer_load_dwordx4 v12, s[40:43], s69 offen lds
    s_add_u32 s69, s69, 53248
    s_waitcnt vmcnt(11)
    s_barrier
    s_add_u32 m0, s63, 64512
    s_nop 0
    buffer_load_dwordx4 v94, s[36:39], 0 offen lds
    s_add_u32 m0, s63, 65536
    s_nop 0
    buffer_load_dwordx4 v95, s[36:39], 0 offen lds
    s_cmp_lg_u32 s66, 3
    s_cbranch_scc1 L_q15
    s_mov_b32 m0, 84992
    s_nop 0
    buffer_load_dwordx4 v9, s[40:43], s69 offen lds
L_q15:
    s_add_u32 m0, s62, 64512
    s_nop 0
    buffer_load_dwordx4 v10, s[40:43], s69 offen lds
    s_add_u32 m0, s62, 65536
    s_nop 0
    buffer_load_dwordx4 v11, s[40:43], s69 offen lds
    s_add_u32 m0, s62, 66560
    s_nop 0
    buffer_load_dwordx4 v12, s[40:43], s69 offen lds
    s_add_u32 s69, s69, 53248
    s_waitcnt vmcnt(10)
    s_barrier
    s_add_u32 m0, s63, 86016
    s_nop 0
    buffer_load_dwordx4 v96, s[36:39], 0 offen lds
    s_add_u32 m0, s63, 87040
    s_nop 0
    buffer_load_dwordx4 v97, s[36:39], 0 offen lds
    s_cmp_lg_u32 s66, 0
    s_cbranch_scc1 L_q16
    s_mov_b32 m0, 106496
    s_nop 0
    buffer_load_dwordx4 v9, s[40:43], s69 offen lds
L_q16:
    s_add_u32 m0, s62, 86016
    s_nop 0
    buffer_load_dwordx4 v10, s[40:43], s69 offen lds
    s_add_u32 m0, s62, 87040
    s_nop 0
    buffer_load_dwordx4 v11, s[40:43], s69 offen lds
    s_add_u32 m0, s62, 88064
    s_nop 0
    buffer_load_dwordx4 v12, s[40:43], s69 offen lds
    s_add_u32 s69, s69, 53248
    s_waitcnt vmcnt(10)
    s_barrier
    s_add_u32 m0, s63, 107520
    s_nop 0
    buffer_load_dwordx4 v98, s[36:39], 0 offen lds
    s_add_u32 m0, s63, 108544
    s_nop 0
    buffer_load_dwordx4 v99, s[36:39], 0 offen lds
    s_cmp_lg_u32 s66, 1
    s_cbranch_scc1 L_q17
    s_mov_b32 m0, 128000
    s_nop 0
    buffer_load_dwordx4 v9, s[40:43], s69 offen lds
L_q17:
    s_add_u32 m0, s62, 107520
    s_nop 0
    buffer_load_dwordx4 v10, s[40:43], s69 offen lds
    s_add_u32 m0, s62, 108544
    s_nop 0
    buffer_load_dwordx4 v11, s[40:43], s69 offen lds
    s_add_u32 m0, s62, 109568
    s_nop 0
    buffer_load_dwordx4 v12, s[40:43], s69 offen lds
    s_add_u32 s69, s69, 53248
    s_waitcnt vmcnt(10)
    s_barrier
L_ld2:
    s_add_u32 m0, s63, 0
    s_nop 0
    buffer_load_dwordx4 v100, s[36:39], 0 offen lds
    s_add_u32 m0, s63, 1024
    s_nop 0
    buffer_load_dwordx4 v101, s[36:39], 0 offen lds
    s_cmp_lg_u32 s66, 2
    s_cbranch_scc1 L_q18
    s_mov_b32 m0, 20480
    s_nop 0
    buffer_load_dwordx4 v9, s[40:43], s69 offen lds
L_q18:
    s_add_u32 m0, s62, 0
    s_nop 0
    buffer_load_dwordx4 v10, s[40:43], s69 offen lds
    s_add_u32 m0, s62, 1024
    s_nop 0
    buffer_load_dwordx4 v11, s[40:43], s69 offen lds
    s_add_u32 m0, s62, 2048
    s_nop 0
    buffer_load_dwordx4 v12, s[40:43], s69 offen lds
    s_add_u32 s69, s69, 53248
    s_waitcnt vmcnt(10)
    s_barrier
    s_add_u32 m0, s63, 21504
    s_nop 0
    buffer_load_dwordx4 v102, s[36:39], 0 offen lds
    s_add_u32 m0, s63, 22528
    s_nop 0
    buffer_load_dwordx4 v103, s[36:39], 0 offen lds
    s_cmp_lg_u32 s66, 3
    s_cbranch_scc1 L_q19
    s_mov_b32 m0, 41984
    s_nop 0
    buffer_load_dwordx4 v9, s[40:43], s69 offen lds
L_q19:
    s_add_u32 m0, s62, 21504
    s_nop 0
    buffer_load_dwordx4 v10, s[40:43], s69 offen lds
    s_add_u32 m0, s62, 22528
    s_nop 0
    buffer_load_dwordx4 v11, s[40:43], s69 offen lds
    s_add_u32 m0, s62, 23552
    s_nop 0
    buffer_load_dwordx4 v12, s[40:43], s69 offen lds
    s_add_u32 s69, s69, 53248
    s_waitcnt vmcnt(10)
    s_barrier
    s_add_u32 m0, s63, 43008
    s_nop 0
    buffer_load_dwordx4 v104, s[36:39], 0 offen lds
    s_add_u32 m0, s63, 44032
    s_nop 0
    buffer_load_dwordx4 v105, s[36:39], 0 offen lds
    s_cmp_lg_u32 s66, 0
    s_cbranch_scc1 L_q20
    s_mov_b32 m0, 63488
    s_nop 0
    buffer_load_dwordx4 v9, s[40:43], s69 offen lds
L_q20:
    s_add_u32 m0, s62, 43008
    s_nop 0
    buffer_load_dwordx4 v10, s[40:43], s69 offen lds
    s_add_u32 m0, s62, 44032
    s_nop 0
    buffer_load_dwordx4 v11, s[40:43], s69 offen lds
    s_add_u32 m0, s62, 45056
    s_nop 0
    buffer_load_dwordx4 v12, s[40:43], s69 offen lds
    s_add_u32 s69, s69, 53248
    s_waitcnt vmcnt(10)
    s_barrier
    s_add_u32 m0, s63, 64512
    s_nop 0
    buffer_load_dwordx4 v106, s[36:39], 0 offen lds
    s_add_u32 m0, s63, 65536
    s_nop 0
    buffer_load_dwordx4 v107, s[36:39], 0 offen lds
    s_cmp_lg_u32 s66, 1
    s_cbranch_scc1 L_q21
    s_mov_b32 m0, 84992
    s_nop 0
    buffer_load_dwordx4 v9, s[40:43], s69 offen lds
L_q21:
    s_add_u32 m0, s62, 64512
    s_nop 0
    buffer_load_dwordx4 v10, s[40:43], s69 offen lds
    s_add_u32 m0, s62, 65536
    s_nop 0
    buffer_load_dwordx4 v11, s[40:43], s69 offen lds
    s_add_u32 m0, s62, 66560
    s_nop 0
    buffer_load_dwordx4 v12, s[40:43], s69 offen lds
    s_add_u32 s69, s69, 53248
    s_waitcnt vmcnt(10)
    s_barrier
    s_add_u32 m0, s63, 86016
    s_nop 0
    buffer_load_dwordx4 v108, s[36:39], 0 offen lds
    s_add_u32 m0, s63, 87040
    s_nop 0
    buffer_load_dwordx4 v109, s[36:39], 0 offen lds
    s_cmp_lg_u32 s66, 2
    s_cbranch_scc1 L_q22
    s_mov_b32 m0, 106496
    s_nop 0
    buffer_load_dwordx4 v9, s[40:43], s69 offen lds
L_q22:
    s_add_u32 m0, s62, 86016
    s_nop 0
    buffer_load_dwordx4 v10, s[40:43], s69 offen lds
    s_add_u32 m0, s62, 87040
    s_nop 0
    buffer_load_dwordx4 v11, s[40:43], s69 offen lds
    s_add_u32 m0, s62, 88064
    s_nop 0
    buffer_load_dwordx4 v12, s[40:43], s69 offen lds
    s_add_u32 s69, s69, 53248
    s_waitcnt vmcnt(10)
    s_barrier
    s_add_u32 m0, s63, 107520
    s_nop 0
    buffer_load_dwordx4 v110, s[36:39], 0 offen lds
    s_add_u32 m0, s63, 108544
    s_nop 0
    buffer_load_dwordx4 v111, s[36:39], 0 offen lds
    s_cmp_lg_u32 s66, 3
    s_cbranch_scc1 L_q23
    s_mov_b32 m0, 128000
    s_nop 0
    buffer_load_dwordx4 v9, s[40:43], s69 offen lds
L_q23:
    s_add_u32 m0, s62, 107520
    s_nop 0
    buffer_load_dwordx4 v10, s[40:43], s69 offen lds
    s_add_u32 m0, s62, 108544
    s_nop 0
    buffer_load_dwordx4 v11, s[40:43], s69 offen lds
    s_add_u32 m0, s62, 109568
    s_nop 0
    buffer_load_dwordx4 v12, s[40:43], s69 offen lds
    s_add_u32 s69, s69, 53248
    s_waitcnt vmcnt(10)
    s_barrier
    s_add_u32 m0, s63, 0
    s_nop 0
    buffer_load_dwordx4 v112, s[36:39], 0 offen lds
    s_add_u32 m0, s63, 1024
    s_nop 0
    buffer_load_dwordx4 v113, s[36:39], 0 offen lds
    s_cmp_lg_u32 s66, 0
    s_cbranch_scc1 L_q24
    s_mov_b32 m0, 20480
    s_nop 0
    buffer_load_dwordx4 v9, s[40:43], s69 offen lds
L_q24:
    s_add_u32 m0, s62, 0
    s_nop 0
    buffer_load_dwordx4 v10, s[40:43], s69 offen lds
    s_add_u32 m0, s62, 1024
    s_nop 0
    buffer_load_dwordx4 v11, s[40:43], s69 offen lds
    s_add_u32 m0, s62, 2048
    s_nop 0
    buffer_load_dwordx4 v12, s[40:43], s69 offen lds
    s_add_u32 s69, s69, 53248
    s_waitcnt vmcnt(10)
    s_barrier
    s_add_u32 m0, s63, 21504
    s_nop 0
    buffer_load_dwordx4 v114, s[36:39], 0 offen lds
    s_add_u32 m0, s63, 22528
    s_nop 0
    buffer_load_dwordx4 v115, s[36:39], 0 offen lds
    s_cmp_lg_u32 s66, 1
    s_cbranch_scc1 L_q25
    s_mov_b32 m0, 41984
    s_nop 0
    buffer_load_dwordx4 v9, s[40:43], s69 offen lds
L_q25:
    s_add_u32 m0, s62, 21504
    s_nop 0
    buffer_load_dwordx4 v10, s[40:43], s69 offen lds
    s_add_u32 m0, s62, 22528
    s_nop 0
    buffer_load_dwordx4 v11, s[40:43], s69 offen lds
    s_add_u32 m0, s62, 23552
    s_nop 0
    buffer_load_dwordx4 v12, s[40:43], s69 offen lds
    s_add_u32 s69, s69, 53248
    s_cmp_eq_u32 s69, 1384448
    s_cselect_b32 s69, 0, s69
    s_waitcnt vmcnt(10)
    s_barrier
    s_waitcnt vmcnt(5)
    s_barrier
    s_waitcnt vmcnt(0)
    s_barrier
    s_cmp_lg_u32 s66, 0
    s_cbranch_scc1 L_noat
    s_lshl_b32 s64, s29, 2
    s_mov_b64 exec, 1
    buffer_atomic_add v32, off, s[52:55], s64
    s_mov_b64 exec, -1
L_noat:
    s_barrier
    s_endpgm
.p2align 12
.fill 672, 4, 0xbf800000
L_comp:
    s_and_b32 s3, s26, 3
    s_and_b32 s66, s3, 1
    s_lshr_b32 s67, s3, 1
    v_and_b32 v1, 15, v0
    v_lshrrev_b32 v2, 4, v0
    v_bfe_u32 v3, v0, 2, 1
    v_lshlrev_b32 v3, 1, v3
    v_xor_b32 v3, v3, v2
    v_lshlrev_b32 v3, 4, v3
    v_lshl_add_u32 v3, v1, 6, v3
    s_lshl_b32 s64, s66, 12
    s_lshl_b32 s65, s67, 11
    s_add_u32 s64, s64, s65
    v_add_u32 v4, s64, v3
    v_xor_b32 v5, 0x800, v4
    v_lshrrev_b32 v3, 5, v0
    v_bfe_u32 v8, v0, 4, 1
    v_lshlrev_b32 v3, 4, v3
    v_lshl_add_u32 v3, v8, 2, v3
    v_bfe_u32 v8, v0, 2, 2
    v_add_u32 v3, v3, v8
    v_mul_u32_u24 v3, 416, v3
    v_and_b32 v8, 3, v0
    v_lshl_add_u32 v3, v8, 3, v3
    s_mul_i32 s64, s67, 224
    s_add_u32 s64, s64, 8192
    v_add_u32 v6, s64, v3
    v_add_u32 v7, 8384, v3
    s_mul_i32 s64, s30, 416
    s_mul_i32 s65, s67, 192
    s_add_u32 s64, s64, s65
    v_lshl_add_u32 v8, v0, 3, s64
    s_mul_i32 s65, s3, 896
    s_add_u32 s65, s65, 142336
    v_lshl_add_u32 v9, v0, 4, s65
    v_lshl_add_u32 v11, v2, 4, s65
    s_lshl_b32 s64, s67, 6
    v_add_u32 v10, s64, v11
    s_mul_i32 s64, s67, 384
    s_sub_u32 s64, 384, s64
    v_add_u32 v11, s64, v11
    s_waitcnt lgkmcnt(0)
    s_mov_b64 exec, 0xfffffff
    global_load_dwordx2 v[12:13], v8, s[14:15]
    global_load_dwordx2 v[14:15], v8, s[16:17]
    s_mov_b64 exec, -1
    s_mov_b32 s44, s24
    s_mov_b32 s45, s25
    s_mov_b32 s46, 131072
    s_mov_b32 s47, 0x20000
    s_lshl_b32 s64, s29, 12
    s_lshl_b32 s65, s30, 10
    s_add_u32 s64, s64, s65
    s_lshl_b32 s65, s67, 9
    s_add_u32 s64, s64, s65
    s_lshl_b32 s65, s66, 8
    s_add_u32 s64, s64, s65
    s_add_u32 s64, s64, 0
    s_lshl_b32 s65, s67, 5
    v_xor_b32 v1, s65, v0
    v_lshl_add_u32 v244, v1, 2, s64
    s_waitcnt vmcnt(0)
    s_mov_b64 exec, 0xfffffff
    v_lshlrev_b32 v16, 16, v12
    v_and_b32 v17, 0xffff0000, v12
    v_lshlrev_b32 v18, 16, v13
    v_and_b32 v19, 0xffff0000, v13
    v_lshlrev_b32 v20, 16, v14
    v_and_b32 v21, 0xffff0000, v14
    v_lshlrev_b32 v22, 16, v15
    v_and_b32 v23, 0xffff0000, v15
    ds_write_b128 v9, v[16:19]
    ds_write_b128 v9, v[20:23] offset:448
    s_mov_b64 exec, -1
    s_waitcnt lgkmcnt(0)
    ds_read_b128 v[104:107], v10 offset:0
    ds_read_b128 v[108:111], v10 offset:0
    ds_read_b128 v[112:115], v10 offset:0
    ds_read_b128 v[116:119], v10 offset:0
    ds_read_b128 v[208:211], v10 offset:448
    ds_read_b128 v[120:123], v10 offset:64
    ds_read_b128 v[124:127], v10 offset:64
    ds_read_b128 v[128:131], v10 offset:64
    ds_read_b128 v[132:135], v10 offset:64
    ds_read_b128 v[212:215], v10 offset:512
    ds_read_b128 v[136:139], v10 offset:128
    ds_read_b128 v[140:143], v10 offset:128
    ds_read_b128 v[144:147], v10 offset:128
    ds_read_b128 v[148:151], v10 offset:128
    ds_read_b128 v[216:219], v10 offset:576
    ds_read_b128 v[152:155], v10 offset:192
    ds_read_b128 v[156:159], v10 offset:192
    ds_read_b128 v[160:163], v10 offset:192
    ds_read_b128 v[164:167], v10 offset:192
    ds_read_b128 v[220:223], v10 offset:640
    ds_read_b128 v[168:171], v10 offset:256
    ds_read_b128 v[172:175], v10 offset:256
    ds_read_b128 v[176:179], v10 offset:256
    ds_read_b128 v[180:183], v10 offset:256
    ds_read_b128 v[224:227], v10 offset:704
    ds_read_b128 v[184:187], v10 offset:320
    ds_read_b128 v[188:191], v10 offset:320
    ds_read_b128 v[192:195], v10 offset:320
    ds_read_b128 v[196:199], v10 offset:320
    ds_read_b128 v[228:231], v10 offset:768
    ds_read_b128 v[200:203], v11 offset:0
    ds_read_b128 v[204:207], v11 offset:0
    ds_read_b128 v[232:235], v11 offset:448
    s_mov_b32 s66, 1
    s_mov_b32 s67, 13
    s_mov_b32 s68, -107520
    s_mov_b32 s69, 21504
    s_mov_b32 s62, 0xbdd2d3e8
    s_mov_b32 s63, 0xbdd2d3e8
    v_mov_b32 v8, 0xc0135761
    v_mov_b32 v9, 0xc0135761
    v_mov_b64 v[236:237], 0
    v_mov_b64 v[238:239], 0
    v_mov_b64 v[240:241], 0
    v_mov_b64 v[242:243], 0
    s_waitcnt lgkmcnt(0)
    s_setprio 1
    s_barrier
    ds_read_b128 v[16:19], v4 offset:0
    ds_read_b64_tr_b16 v[32:33], v6 offset:0
    ds_read_b64_tr_b16 v[34:35], v6 offset:3328
    ds_read_b128 v[20:23], v4 offset:1024
    ds_read_b128 v[24:27], v5 offset:0
    ds_read_b128 v[28:31], v5 offset:1024
    ds_read_b64_tr_b16 v[36:37], v6 offset:32
    ds_read_b64_tr_b16 v[38:39], v6 offset:3360
    ds_read_b64_tr_b16 v[40:41], v6 offset:64
    ds_read_b64_tr_b16 v[42:43], v6 offset:3392
    ds_read_b64_tr_b16 v[44:45], v6 offset:96
    ds_read_b64_tr_b16 v[46:47], v6 offset:3424
    ds_read_b64_tr_b16 v[48:49], v6 offset:128
    ds_read_b64_tr_b16 v[50:51], v6 offset:3456
    ds_read_b64_tr_b16 v[52:53], v6 offset:160
    ds_read_b64_tr_b16 v[54:55], v6 offset:3488
    ds_read_b64_tr_b16 v[56:57], v7 offset:0
    ds_read_b64_tr_b16 v[58:59], v7 offset:3328
    s_mov_b32 s66, 0
L_dloop:
    s_waitcnt lgkmcnt(12)
    v_mfma_f32_16x16x32_bf16 v[104:107], v[32:35], v[16:19], v[104:107]
    s_add_u32 s66, s66, 1
    s_cmp_eq_u32 s66, 6
    v_mfma_f32_16x16x32_bf16 v[108:111], v[32:35], v[20:23], v[108:111]
    s_cselect_b32 s64, s68, s69
    s_cselect_b32 s66, 0, s66
    v_mfma_f32_16x16x32_bf16 v[112:115], v[32:35], v[24:27], v[112:115]
    v_add_u32 v4, s64, v4
    v_add_u32 v5, s64, v5
    v_mfma_f32_16x16x32_bf16 v[116:119], v[32:35], v[28:31], v[116:119]
    v_add_u32 v6, s64, v6
    v_add_u32 v7, s64, v7
    s_waitcnt lgkmcnt(0)
    s_barrier
    v_mfma_f32_16x16x32_bf16 v[132:135], v[36:39], v[28:31], v[132:135]
    ds_read_b128 v[60:63], v4 offset:0
    v_mfma_f32_16x16x32_bf16 v[128:131], v[36:39], v[24:27], v[128:131]
    ds_read_b64_tr_b16 v[76:77], v6 offset:0
    v_mfma_f32_16x16x32_bf16 v[124:127], v[36:39], v[20:23], v[124:127]
    ds_read_b64_tr_b16 v[78:79], v6 offset:3328
    v_mfma_f32_16x16x32_bf16 v[120:123], v[36:39], v[16:19], v[120:123]
    ds_read_b128 v[64:67], v4 offset:1024
    v_mfma_f32_16x16x32_bf16 v[136:139], v[40:43], v[16:19], v[136:139]
    ds_read_b128 v[68:71], v5 offset:0
    v_mfma_f32_16x16x32_bf16 v[140:143], v[40:43], v[20:23], v[140:143]
    ds_read_b128 v[72:75], v5 offset:1024
    v_mfma_f32_16x16x32_bf16 v[144:147], v[40:43], v[24:27], v[144:147]
    ds_read_b64_tr_b16 v[80:81], v6 offset:32
    v_mfma_f32_16x16x32_bf16 v[148:151], v[40:43], v[28:31], v[148:151]
    ds_read_b64_tr_b16 v[82:83], v6 offset:3360
    v_mfma_f32_16x16x32_bf16 v[164:167], v[44:47], v[28:31], v[164:167]
    ds_read_b64_tr_b16 v[84:85], v6 offset:64
    v_mfma_f32_16x16x32_bf16 v[160:163], v[44:47], v[24:27], v[160:163]
    ds_read_b64_tr_b16 v[86:87], v6 offset:3392
    v_mfma_f32_16x16x32_bf16 v[156:159], v[44:47], v[20:23], v[156:159]
    ds_read_b64_tr_b16 v[88:89], v6 offset:96
    v_mfma_f32_16x16x32_bf16 v[152:155], v[44:47], v[16:19], v[152:155]
    ds_read_b64_tr_b16 v[90:91], v6 offset:3424
    v_mfma_f32_16x16x32_bf16 v[168:171], v[48:51], v[16:19], v[168:171]
    ds_read_b64_tr_b16 v[92:93], v6 offset:128
    v_mfma_f32_16x16x32_bf16 v[172:175], v[48:51], v[20:23], v[172:175]
    ds_read_b64_tr_b16 v[94:95], v6 offset:3456
    v_mfma_f32_16x16x32_bf16 v[176:179], v[48:51], v[24:27], v[176:179]
    ds_read_b64_tr_b16 v[96:97], v6 offset:160
    v_mfma_f32_16x16x32_bf16 v[180:183], v[48:51], v[28:31], v[180:183]
    ds_read_b64_tr_b16 v[98:99], v6 offset:3488
    v_mfma_f32_16x16x32_bf16 v[196:199], v[52:55], v[28:31], v[196:199]
    ds_read_b64_tr_b16 v[100:101], v7 offset:0
    v_mfma_f32_16x16x32_bf16 v[192:195], v[52:55], v[24:27], v[192:195]
    ds_read_b64_tr_b16 v[102:103], v7 offset:3328
    v_mfma_f32_16x16x32_bf16 v[188:191], v[52:55], v[20:23], v[188:191]
    v_mfma_f32_16x16x32_bf16 v[184:187], v[52:55], v[16:19], v[184:187]
    v_mfma_f32_16x16x32_bf16 v[200:203], v[56:59], v[16:19], v[200:203]
    v_mfma_f32_16x16x32_bf16 v[204:207], v[56:59], v[20:23], v[204:207]
    s_waitcnt lgkmcnt(12)
    v_mfma_f32_16x16x32_bf16 v[104:107], v[76:79], v[60:63], v[104:107]
    s_add_u32 s66, s66, 1
    s_cmp_eq_u32 s66, 6
    v_mfma_f32_16x16x32_bf16 v[108:111], v[76:79], v[64:67], v[108:111]
    s_cselect_b32 s64, s68, s69
    s_cselect_b32 s66, 0, s66
    v_mfma_f32_16x16x32_bf16 v[112:115], v[76:79], v[68:71], v[112:115]
    v_add_u32 v4, s64, v4
    v_add_u32 v5, s64, v5
    v_mfma_f32_16x16x32_bf16 v[116:119], v[76:79], v[72:75], v[116:119]
    v_add_u32 v6, s64, v6
    v_add_u32 v7, s64, v7
    s_waitcnt lgkmcnt(0)
    s_barrier
    v_mfma_f32_16x16x32_bf16 v[132:135], v[80:83], v[72:75], v[132:135]
    ds_read_b128 v[16:19], v4 offset:0
    v_mfma_f32_16x16x32_bf16 v[128:131], v[80:83], v[68:71], v[128:131]
    ds_read_b64_tr_b16 v[32:33], v6 offset:0
    v_mfma_f32_16x16x32_bf16 v[124:127], v[80:83], v[64:67], v[124:127]
    ds_read_b64_tr_b16 v[34:35], v6 offset:3328
    v_mfma_f32_16x16x32_bf16 v[120:123], v[80:83], v[60:63], v[120:123]
    ds_read_b128 v[20:23], v4 offset:1024
    v_mfma_f32_16x16x32_bf16 v[136:139], v[84:87], v[60:63], v[136:139]
    ds_read_b128 v[24:27], v5 offset:0
    v_mfma_f32_16x16x32_bf16 v[140:143], v[84:87], v[64:67], v[140:143]
    ds_read_b128 v[28:31], v5 offset:1024
    v_mfma_f32_16x16x32_bf16 v[144:147], v[84:87], v[68:71], v[144:147]
    ds_read_b64_tr_b16 v[36:37], v6 offset:32
    v_mfma_f32_16x16x32_bf16 v[148:151], v[84:87], v[72:75], v[148:151]
    ds_read_b64_tr_b16 v[38:39], v6 offset:3360
    v_mfma_f32_16x16x32_bf16 v[164:167], v[88:91], v[72:75], v[164:167]
    ds_read_b64_tr_b16 v[40:41], v6 offset:64
    v_mfma_f32_16x16x32_bf16 v[160:163], v[88:91], v[68:71], v[160:163]
    ds_read_b64_tr_b16 v[42:43], v6 offset:3392
    v_mfma_f32_16x16x32_bf16 v[156:159], v[88:91], v[64:67], v[156:159]
    ds_read_b64_tr_b16 v[44:45], v6 offset:96
    v_mfma_f32_16x16x32_bf16 v[152:155], v[88:91], v[60:63], v[152:155]
    ds_read_b64_tr_b16 v[46:47], v6 offset:3424
    v_mfma_f32_16x16x32_bf16 v[168:171], v[92:95], v[60:63], v[168:171]
    ds_read_b64_tr_b16 v[48:49], v6 offset:128
    v_mfma_f32_16x16x32_bf16 v[172:175], v[92:95], v[64:67], v[172:175]
    ds_read_b64_tr_b16 v[50:51], v6 offset:3456
    v_mfma_f32_16x16x32_bf16 v[176:179], v[92:95], v[68:71], v[176:179]
    ds_read_b64_tr_b16 v[52:53], v6 offset:160
    v_mfma_f32_16x16x32_bf16 v[180:183], v[92:95], v[72:75], v[180:183]
    ds_read_b64_tr_b16 v[54:55], v6 offset:3488
    v_mfma_f32_16x16x32_bf16 v[196:199], v[96:99], v[72:75], v[196:199]
    ds_read_b64_tr_b16 v[56:57], v7 offset:0
    v_mfma_f32_16x16x32_bf16 v[192:195], v[96:99], v[68:71], v[192:195]
    ds_read_b64_tr_b16 v[58:59], v7 offset:3328
    v_mfma_f32_16x16x32_bf16 v[188:191], v[96:99], v[64:67], v[188:191]
    s_sub_u32 s67, s67, 1
    s_cmp_lg_u32 s67, 0
    v_mfma_f32_16x16x32_bf16 v[184:187], v[96:99], v[60:63], v[184:187]
    v_mfma_f32_16x16x32_bf16 v[200:203], v[100:103], v[60:63], v[200:203]
    v_mfma_f32_16x16x32_bf16 v[204:207], v[100:103], v[64:67], v[204:207]
    s_cbranch_scc1 L_dloop
    s_waitcnt lgkmcnt(0)
    v_pk_mul_f32 v[16:17], v[104:105], v[104:105]
    v_pk_mul_f32 v[18:19], v[106:107], v[106:107]
    v_pk_mul_f32 v[20:21], v[108:109], v[108:109]
    v_pk_mul_f32 v[22:23], v[110:111], v[110:111]
    v_pk_fma_f32 v[16:17], v[16:17], s[62:63], v[8:9]
    v_pk_fma_f32 v[18:19], v[18:19], s[62:63], v[8:9]
    v_pk_fma_f32 v[20:21], v[20:21], s[62:63], v[8:9]
    v_pk_fma_f32 v[22:23], v[22:23], s[62:63], v[8:9]
    v_pk_mul_f32 v[16:17], v[16:17], v[104:105]
    v_pk_mul_f32 v[18:19], v[18:19], v[106:107]
    v_pk_mul_f32 v[20:21], v[20:21], v[108:109]
    v_pk_mul_f32 v[22:23], v[22:23], v[110:111]
    v_exp_f32 v16, v16
    v_exp_f32 v17, v17
    v_exp_f32 v18, v18
    v_exp_f32 v19, v19
    v_exp_f32 v20, v20
    v_exp_f32 v21, v21
    v_exp_f32 v22, v22
    v_exp_f32 v23, v23
    v_pk_mul_f32 v[104:105], v[104:105], v[208:209]
    v_pk_mul_f32 v[106:107], v[106:107], v[210:211]
    v_pk_mul_f32 v[108:109], v[108:109], v[208:209]
    v_pk_mul_f32 v[110:111], v[110:111], v[210:211]
    v_pk_add_f32 v[16:17], v[16:17], 1.0 op_sel_hi:[1,0]
    v_pk_add_f32 v[18:19], v[18:19], 1.0 op_sel_hi:[1,0]
    v_pk_add_f32 v[20:21], v[20:21], 1.0 op_sel_hi:[1,0]
    v_pk_add_f32 v[22:23], v[22:23], 1.0 op_sel_hi:[1,0]
    v_rcp_f32 v16, v16
    v_rcp_f32 v17, v17
    v_rcp_f32 v18, v18
    v_rcp_f32 v19, v19
    v_rcp_f32 v20, v20
    v_rcp_f32 v21, v21
    v_rcp_f32 v22, v22
    v_rcp_f32 v23, v23
L_gl2:
    v_pk_mul_f32 v[24:25], v[112:113], v[112:113]
    v_pk_mul_f32 v[26:27], v[114:115], v[114:115]
    v_pk_mul_f32 v[28:29], v[116:117], v[116:117]
    v_pk_mul_f32 v[30:31], v[118:119], v[118:119]
    v_pk_fma_f32 v[24:25], v[24:25], s[62:63], v[8:9]
    v_pk_fma_f32 v[26:27], v[26:27], s[62:63], v[8:9]
    v_pk_fma_f32 v[28:29], v[28:29], s[62:63], v[8:9]
    v_pk_fma_f32 v[30:31], v[30:31], s[62:63], v[8:9]
    v_pk_mul_f32 v[24:25], v[24:25], v[112:113]
    v_pk_mul_f32 v[26:27], v[26:27], v[114:115]
    v_pk_mul_f32 v[28:29], v[28:29], v[116:117]
    v_pk_mul_f32 v[30:31], v[30:31], v[118:119]
    v_exp_f32 v24, v24
    v_exp_f32 v25, v25
    v_exp_f32 v26, v26
    v_exp_f32 v27, v27
    v_exp_f32 v28, v28
    v_exp_f32 v29, v29
    v_exp_f32 v30, v30
    v_exp_f32 v31, v31
    v_pk_mul_f32 v[112:113], v[112:113], v[208:209]
    v_pk_mul_f32 v[114:115], v[114:115], v[210:211]
    v_pk_mul_f32 v[116:117], v[116:117], v[208:209]
    v_pk_mul_f32 v[118:119], v[118:119], v[210:211]
    v_pk_add_f32 v[24:25], v[24:25], 1.0 op_sel_hi:[1,0]
    v_pk_add_f32 v[26:27], v[26:27], 1.0 op_sel_hi:[1,0]
    v_pk_add_f32 v[28:29], v[28:29], 1.0 op_sel_hi:[1,0]
    v_pk_add_f32 v[30:31], v[30:31], 1.0 op_sel_hi:[1,0]
    v_rcp_f32 v24, v24
    v_rcp_f32 v25, v25
    v_rcp_f32 v26, v26
    v_rcp_f32 v27, v27
    v_rcp_f32 v28, v28
    v_rcp_f32 v29, v29
    v_rcp_f32 v30, v30
    v_rcp_f32 v31, v31
    v_pk_fma_f32 v[236:237], v[104:105], v[16:17], v[236:237]
    v_pk_fma_f32 v[238:239], v[108:109], v[20:21], v[238:239]
    v_pk_fma_f32 v[236:237], v[106:107], v[18:19], v[236:237]
    v_pk_fma_f32 v[238:239], v[110:111], v[22:23], v[238:239]
    v_pk_mul_f32 v[16:17], v[120:121], v[120:121]
    v_pk_mul_f32 v[18:19], v[122:123], v[122:123]
    v_pk_mul_f32 v[20:21], v[124:125], v[124:125]
    v_pk_mul_f32 v[22:23], v[126:127], v[126:127]
    v_pk_fma_f32 v[16:17], v[16:17], s[62:63], v[8:9]
    v_pk_fma_f32 v[18:19], v[18:19], s[62:63], v[8:9]
    v_pk_fma_f32 v[20:21], v[20:21], s[62:63], v[8:9]
    v_pk_fma_f32 v[22:23], v[22:23], s[62:63], v[8:9]
    v_pk_mul_f32 v[16:17], v[16:17], v[120:121]
    v_pk_mul_f32 v[18:19], v[18:19], v[122:123]
    v_pk_mul_f32 v[20:21], v[20:21], v[124:125]
    v_pk_mul_f32 v[22:23], v[22:23], v[126:127]
    v_exp_f32 v16, v16
    v_exp_f32 v17, v17
    v_exp_f32 v18, v18
    v_exp_f32 v19, v19
    v_exp_f32 v20, v20
    v_exp_f32 v21, v21
    v_exp_f32 v22, v22
    v_exp_f32 v23, v23
    v_pk_mul_f32 v[120:121], v[120:121], v[212:213]
    v_pk_mul_f32 v[122:123], v[122:123], v[214:215]
    v_pk_mul_f32 v[124:125], v[124:125], v[212:213]
    v_pk_mul_f32 v[126:127], v[126:127], v[214:215]
    v_pk_add_f32 v[16:17], v[16:17], 1.0 op_sel_hi:[1,0]
    v_pk_add_f32 v[18:19], v[18:19], 1.0 op_sel_hi:[1,0]
    v_pk_add_f32 v[20:21], v[20:21], 1.0 op_sel_hi:[1,0]
    v_pk_add_f32 v[22:23], v[22:23], 1.0 op_sel_hi:[1,0]
    v_rcp_f32 v16, v16
    v_rcp_f32 v17, v17
    v_rcp_f32 v18, v18
    v_rcp_f32 v19, v19
    v_rcp_f32 v20, v20
    v_rcp_f32 v21, v21
    v_rcp_f32 v22, v22
    v_rcp_f32 v23, v23
    v_pk_fma_f32 v[240:241], v[112:113], v[24:25], v[240:241]
    v_pk_fma_f32 v[242:243], v[116:117], v[28:29], v[242:243]
    v_pk_fma_f32 v[240:241], v[114:115], v[26:27], v[240:241]
    v_pk_fma_f32 v[242:243], v[118:119], v[30:31], v[242:243]
    v_pk_mul_f32 v[24:25], v[128:129], v[128:129]
    v_pk_mul_f32 v[26:27], v[130:131], v[130:131]
    v_pk_mul_f32 v[28:29], v[132:133], v[132:133]
    v_pk_mul_f32 v[30:31], v[134:135], v[134:135]
    v_pk_fma_f32 v[24:25], v[24:25], s[62:63], v[8:9]
    v_pk_fma_f32 v[26:27], v[26:27], s[62:63], v[8:9]
    v_pk_fma_f32 v[28:29], v[28:29], s[62:63], v[8:9]
    v_pk_fma_f32 v[30:31], v[30:31], s[62:63], v[8:9]
    v_pk_mul_f32 v[24:25], v[24:25], v[128:129]
    v_pk_mul_f32 v[26:27], v[26:27], v[130:131]
    v_pk_mul_f32 v[28:29], v[28:29], v[132:133]
    v_pk_mul_f32 v[30:31], v[30:31], v[134:135]
    v_exp_f32 v24, v24
    v_exp_f32 v25, v25
    v_exp_f32 v26, v26
    v_exp_f32 v27, v27
    v_exp_f32 v28, v28
    v_exp_f32 v29, v29
    v_exp_f32 v30, v30
    v_exp_f32 v31, v31
    v_pk_mul_f32 v[128:129], v[128:129], v[212:213]
    v_pk_mul_f32 v[130:131], v[130:131], v[214:215]
    v_pk_mul_f32 v[132:133], v[132:133], v[212:213]
    v_pk_mul_f32 v[134:135], v[134:135], v[214:215]
    v_pk_add_f32 v[24:25], v[24:25], 1.0 op_sel_hi:[1,0]
    v_pk_add_f32 v[26:27], v[26:27], 1.0 op_sel_hi:[1,0]
    v_pk_add_f32 v[28:29], v[28:29], 1.0 op_sel_hi:[1,0]
    v_pk_add_f32 v[30:31], v[30:31], 1.0 op_sel_hi:[1,0]
    v_rcp_f32 v24, v24
    v_rcp_f32 v25, v25
    v_rcp_f32 v26, v26
    v_rcp_f32 v27, v27
    v_rcp_f32 v28, v28
    v_rcp_f32 v29, v29
    v_rcp_f32 v30, v30
    v_rcp_f32 v31, v31
    v_pk_fma_f32 v[236:237], v[120:121], v[16:17], v[236:237]
    v_pk_fma_f32 v[238:239], v[124:125], v[20:21], v[238:239]
    v_pk_fma_f32 v[236:237], v[122:123], v[18:19], v[236:237]
    v_pk_fma_f32 v[238:239], v[126:127], v[22:23], v[238:239]
    v_pk_mul_f32 v[16:17], v[136:137], v[136:137]
    v_pk_mul_f32 v[18:19], v[138:139], v[138:139]
    v_pk_mul_f32 v[20:21], v[140:141], v[140:141]
    v_pk_mul_f32 v[22:23], v[142:143], v[142:143]
    v_pk_fma_f32 v[16:17], v[16:17], s[62:63], v[8:9]
    v_pk_fma_f32 v[18:19], v[18:19], s[62:63], v[8:9]
    v_pk_fma_f32 v[20:21], v[20:21], s[62:63], v[8:9]
    v_pk_fma_f32 v[22:23], v[22:23], s[62:63], v[8:9]
    v_pk_mul_f32 v[16:17], v[16:17], v[136:137]
    v_pk_mul_f32 v[18:19], v[18:19], v[138:139]
    v_pk_mul_f32 v[20:21], v[20:21], v[140:141]
    v_pk_mul_f32 v[22:23], v[22:23], v[142:143]
    v_exp_f32 v16, v16
    v_exp_f32 v17, v17
    v_exp_f32 v18, v18
    v_exp_f32 v19, v19
    v_exp_f32 v20, v20
    v_exp_f32 v21, v21
    v_exp_f32 v22, v22
    v_exp_f32 v23, v23
    v_pk_mul_f32 v[136:137], v[136:137], v[216:217]
    v_pk_mul_f32 v[138:139], v[138:139], v[218:219]
    v_pk_mul_f32 v[140:141], v[140:141], v[216:217]
    v_pk_mul_f32 v[142:143], v[142:143], v[218:219]
    v_pk_add_f32 v[16:17], v[16:17], 1.0 op_sel_hi:[1,0]
    v_pk_add_f32 v[18:19], v[18:19], 1.0 op_sel_hi:[1,0]
    v_pk_add_f32 v[20:21], v[20:21], 1.0 op_sel_hi:[1,0]
    v_pk_add_f32 v[22:23], v[22:23], 1.0 op_sel_hi:[1,0]
    v_rcp_f32 v16, v16
    v_rcp_f32 v17, v17
    v_rcp_f32 v18, v18
    v_rcp_f32 v19, v19
    v_rcp_f32 v20, v20
    v_rcp_f32 v21, v21
    v_rcp_f32 v22, v22
    v_rcp_f32 v23, v23
    v_pk_fma_f32 v[240:241], v[128:129], v[24:25], v[240:241]
    v_pk_fma_f32 v[242:243], v[132:133], v[28:29], v[242:243]
    v_pk_fma_f32 v[240:241], v[130:131], v[26:27], v[240:241]
    v_pk_fma_f32 v[242:243], v[134:135], v[30:31], v[242:243]
    v_pk_mul_f32 v[24:25], v[144:145], v[144:145]
    v_pk_mul_f32 v[26:27], v[146:147], v[146:147]
    v_pk_mul_f32 v[28:29], v[148:149], v[148:149]
    v_pk_mul_f32 v[30:31], v[150:151], v[150:151]
    v_pk_fma_f32 v[24:25], v[24:25], s[62:63], v[8:9]
    v_pk_fma_f32 v[26:27], v[26:27], s[62:63], v[8:9]
    v_pk_fma_f32 v[28:29], v[28:29], s[62:63], v[8:9]
    v_pk_fma_f32 v[30:31], v[30:31], s[62:63], v[8:9]
    v_pk_mul_f32 v[24:25], v[24:25], v[144:145]
    v_pk_mul_f32 v[26:27], v[26:27], v[146:147]
    v_pk_mul_f32 v[28:29], v[28:29], v[148:149]
    v_pk_mul_f32 v[30:31], v[30:31], v[150:151]
    v_exp_f32 v24, v24
    v_exp_f32 v25, v25
    v_exp_f32 v26, v26
    v_exp_f32 v27, v27
    v_exp_f32 v28, v28
    v_exp_f32 v29, v29
    v_exp_f32 v30, v30
    v_exp_f32 v31, v31
    v_pk_mul_f32 v[144:145], v[144:145], v[216:217]
    v_pk_mul_f32 v[146:147], v[146:147], v[218:219]
    v_pk_mul_f32 v[148:149], v[148:149], v[216:217]
    v_pk_mul_f32 v[150:151], v[150:151], v[218:219]
    v_pk_add_f32 v[24:25], v[24:25], 1.0 op_sel_hi:[1,0]
    v_pk_add_f32 v[26:27], v[26:27], 1.0 op_sel_hi:[1,0]
    v_pk_add_f32 v[28:29], v[28:29], 1.0 op_sel_hi:[1,0]
    v_pk_add_f32 v[30:31], v[30:31], 1.0 op_sel_hi:[1,0]
    v_rcp_f32 v24, v24
    v_rcp_f32 v25, v25
    v_rcp_f32 v26, v26
    v_rcp_f32 v27, v27
    v_rcp_f32 v28, v28
    v_rcp_f32 v29, v29
    v_rcp_f32 v30, v30
    v_rcp_f32 v31, v31
    v_pk_fma_f32 v[236:237], v[136:137], v[16:17], v[236:237]
    v_pk_fma_f32 v[238:239], v[140:141], v[20:21], v[238:239]
    v_pk_fma_f32 v[236:237], v[138:139], v[18:19], v[236:237]
    v_pk_fma_f32 v[238:239], v[142:143], v[22:23], v[238:239]
    v_pk_mul_f32 v[16:17], v[152:153], v[152:153]
    v_pk_mul_f32 v[18:19], v[154:155], v[154:155]
    v_pk_mul_f32 v[20:21], v[156:157], v[156:157]
    v_pk_mul_f32 v[22:23], v[158:159], v[158:159]
    v_pk_fma_f32 v[16:17], v[16:17], s[62:63], v[8:9]
    v_pk_fma_f32 v[18:19], v[18:19], s[62:63], v[8:9]
    v_pk_fma_f32 v[20:21], v[20:21], s[62:63], v[8:9]
    v_pk_fma_f32 v[22:23], v[22:23], s[62:63], v[8:9]
    v_pk_mul_f32 v[16:17], v[16:17], v[152:153]
    v_pk_mul_f32 v[18:19], v[18:19], v[154:155]
    v_pk_mul_f32 v[20:21], v[20:21], v[156:157]
    v_pk_mul_f32 v[22:23], v[22:23], v[158:159]
    v_exp_f32 v16, v16
    v_exp_f32 v17, v17
    v_exp_f32 v18, v18
    v_exp_f32 v19, v19
    v_exp_f32 v20, v20
    v_exp_f32 v21, v21
    v_exp_f32 v22, v22
    v_exp_f32 v23, v23
    v_pk_mul_f32 v[152:153], v[152:153], v[220:221]
    v_pk_mul_f32 v[154:155], v[154:155], v[222:223]
    v_pk_mul_f32 v[156:157], v[156:157], v[220:221]
    v_pk_mul_f32 v[158:159], v[158:159], v[222:223]
    v_pk_add_f32 v[16:17], v[16:17], 1.0 op_sel_hi:[1,0]
    v_pk_add_f32 v[18:19], v[18:19], 1.0 op_sel_hi:[1,0]
    v_pk_add_f32 v[20:21], v[20:21], 1.0 op_sel_hi:[1,0]
    v_pk_add_f32 v[22:23], v[22:23], 1.0 op_sel_hi:[1,0]
    v_rcp_f32 v16, v16
    v_rcp_f32 v17, v17
    v_rcp_f32 v18, v18
    v_rcp_f32 v19, v19
    v_rcp_f32 v20, v20
    v_rcp_f32 v21, v21
    v_rcp_f32 v22, v22
    v_rcp_f32 v23, v23
    v_pk_fma_f32 v[240:241], v[144:145], v[24:25], v[240:241]
    v_pk_fma_f32 v[242:243], v[148:149], v[28:29], v[242:243]
    v_pk_fma_f32 v[240:241], v[146:147], v[26:27], v[240:241]
    v_pk_fma_f32 v[242:243], v[150:151], v[30:31], v[242:243]
    v_pk_mul_f32 v[24:25], v[160:161], v[160:161]
    v_pk_mul_f32 v[26:27], v[162:163], v[162:163]
    v_pk_mul_f32 v[28:29], v[164:165], v[164:165]
    v_pk_mul_f32 v[30:31], v[166:167], v[166:167]
    v_pk_fma_f32 v[24:25], v[24:25], s[62:63], v[8:9]
    v_pk_fma_f32 v[26:27], v[26:27], s[62:63], v[8:9]
    v_pk_fma_f32 v[28:29], v[28:29], s[62:63], v[8:9]
    v_pk_fma_f32 v[30:31], v[30:31], s[62:63], v[8:9]
    v_pk_mul_f32 v[24:25], v[24:25], v[160:161]
    v_pk_mul_f32 v[26:27], v[26:27], v[162:163]
    v_pk_mul_f32 v[28:29], v[28:29], v[164:165]
    v_pk_mul_f32 v[30:31], v[30:31], v[166:167]
    v_exp_f32 v24, v24
    v_exp_f32 v25, v25
    v_exp_f32 v26, v26
    v_exp_f32 v27, v27
    v_exp_f32 v28, v28
    v_exp_f32 v29, v29
    v_exp_f32 v30, v30
    v_exp_f32 v31, v31
    v_pk_mul_f32 v[160:161], v[160:161], v[220:221]
    v_pk_mul_f32 v[162:163], v[162:163], v[222:223]
    v_pk_mul_f32 v[164:165], v[164:165], v[220:221]
    v_pk_mul_f32 v[166:167], v[166:167], v[222:223]
    v_pk_add_f32 v[24:25], v[24:25], 1.0 op_sel_hi:[1,0]
    v_pk_add_f32 v[26:27], v[26:27], 1.0 op_sel_hi:[1,0]
    v_pk_add_f32 v[28:29], v[28:29], 1.0 op_sel_hi:[1,0]
    v_pk_add_f32 v[30:31], v[30:31], 1.0 op_sel_hi:[1,0]
    v_rcp_f32 v24, v24
    v_rcp_f32 v25, v25
    v_rcp_f32 v26, v26
    v_rcp_f32 v27, v27
    v_rcp_f32 v28, v28
    v_rcp_f32 v29, v29
    v_rcp_f32 v30, v30
    v_rcp_f32 v31, v31
    v_pk_fma_f32 v[236:237], v[152:153], v[16:17], v[236:237]
    v_pk_fma_f32 v[238:239], v[156:157], v[20:21], v[238:239]
    v_pk_fma_f32 v[236:237], v[154:155], v[18:19], v[236:237]
    v_pk_fma_f32 v[238:239], v[158:159], v[22:23], v[238:239]
    v_pk_mul_f32 v[16:17], v[168:169], v[168:169]
    v_pk_mul_f32 v[18:19], v[170:171], v[170:171]
    v_pk_mul_f32 v[20:21], v[172:173], v[172:173]
    v_pk_mul_f32 v[22:23], v[174:175], v[174:175]
    v_pk_fma_f32 v[16:17], v[16:17], s[62:63], v[8:9]
    v_pk_fma_f32 v[18:19], v[18:19], s[62:63], v[8:9]
    v_pk_fma_f32 v[20:21], v[20:21], s[62:63], v[8:9]
    v_pk_fma_f32 v[22:23], v[22:23], s[62:63], v[8:9]
    v_pk_mul_f32 v[16:17], v[16:17], v[168:169]
    v_pk_mul_f32 v[18:19], v[18:19], v[170:171]
    v_pk_mul_f32 v[20:21], v[20:21], v[172:173]
    v_pk_mul_f32 v[22:23], v[22:23], v[174:175]
    v_exp_f32 v16, v16
    v_exp_f32 v17, v17
    v_exp_f32 v18, v18
    v_exp_f32 v19, v19
    v_exp_f32 v20, v20
    v_exp_f32 v21, v21
    v_exp_f32 v22, v22
    v_exp_f32 v23, v23
    v_pk_mul_f32 v[168:169], v[168:169], v[224:225]
    v_pk_mul_f32 v[170:171], v[170:171], v[226:227]
    v_pk_mul_f32 v[172:173], v[172:173], v[224:225]
    v_pk_mul_f32 v[174:175], v[174:175], v[226:227]
    v_pk_add_f32 v[16:17], v[16:17], 1.0 op_sel_hi:[1,0]
    v_pk_add_f32 v[18:19], v[18:19], 1.0 op_sel_hi:[1,0]
    v_pk_add_f32 v[20:21], v[20:21], 1.0 op_sel_hi:[1,0]
    v_pk_add_f32 v[22:23], v[22:23], 1.0 op_sel_hi:[1,0]
    v_rcp_f32 v16, v16
    v_rcp_f32 v17, v17
    v_rcp_f32 v18, v18
    v_rcp_f32 v19, v19
    v_rcp_f32 v20, v20
    v_rcp_f32 v21, v21
    v_rcp_f32 v22, v22
    v_rcp_f32 v23, v23
    v_pk_fma_f32 v[240:241], v[160:161], v[24:25], v[240:241]
    v_pk_fma_f32 v[242:243], v[164:165], v[28:29], v[242:243]
    v_pk_fma_f32 v[240:241], v[162:163], v[26:27], v[240:241]
    v_pk_fma_f32 v[242:243], v[166:167], v[30:31], v[242:243]
    v_pk_mul_f32 v[24:25], v[176:177], v[176:177]
    v_pk_mul_f32 v[26:27], v[178:179], v[178:179]
    v_pk_mul_f32 v[28:29], v[180:181], v[180:181]
    v_pk_mul_f32 v[30:31], v[182:183], v[182:183]
    v_pk_fma_f32 v[24:25], v[24:25], s[62:63], v[8:9]
    v_pk_fma_f32 v[26:27], v[26:27], s[62:63], v[8:9]
    v_pk_fma_f32 v[28:29], v[28:29], s[62:63], v[8:9]
    v_pk_fma_f32 v[30:31], v[30:31], s[62:63], v[8:9]
    v_pk_mul_f32 v[24:25], v[24:25], v[176:177]
    v_pk_mul_f32 v[26:27], v[26:27], v[178:179]
    v_pk_mul_f32 v[28:29], v[28:29], v[180:181]
    v_pk_mul_f32 v[30:31], v[30:31], v[182:183]
    v_exp_f32 v24, v24
    v_exp_f32 v25, v25
    v_exp_f32 v26, v26
    v_exp_f32 v27, v27
    v_exp_f32 v28, v28
    v_exp_f32 v29, v29
    v_exp_f32 v30, v30
    v_exp_f32 v31, v31
    v_pk_mul_f32 v[176:177], v[176:177], v[224:225]
    v_pk_mul_f32 v[178:179], v[178:179], v[226:227]
    v_pk_mul_f32 v[180:181], v[180:181], v[224:225]
    v_pk_mul_f32 v[182:183], v[182:183], v[226:227]
    v_pk_add_f32 v[24:25], v[24:25], 1.0 op_sel_hi:[1,0]
    v_pk_add_f32 v[26:27], v[26:27], 1.0 op_sel_hi:[1,0]
    v_pk_add_f32 v[28:29], v[28:29], 1.0 op_sel_hi:[1,0]
    v_pk_add_f32 v[30:31], v[30:31], 1.0 op_sel_hi:[1,0]
    v_rcp_f32 v24, v24
    v_rcp_f32 v25, v25
    v_rcp_f32 v26, v26
    v_rcp_f32 v27, v27
    v_rcp_f32 v28, v28
    v_rcp_f32 v29, v29
    v_rcp_f32 v30, v30
    v_rcp_f32 v31, v31
    v_pk_fma_f32 v[236:237], v[168:169], v[16:17], v[236:237]
    v_pk_fma_f32 v[238:239], v[172:173], v[20:21], v[238:239]
    v_pk_fma_f32 v[236:237], v[170:171], v[18:19], v[236:237]
    v_pk_fma_f32 v[238:239], v[174:175], v[22:23], v[238:239]
    v_pk_mul_f32 v[16:17], v[184:185], v[184:185]
    v_pk_mul_f32 v[18:19], v[186:187], v[186:187]
    v_pk_mul_f32 v[20:21], v[188:189], v[188:189]
    v_pk_mul_f32 v[22:23], v[190:191], v[190:191]
    v_pk_fma_f32 v[16:17], v[16:17], s[62:63], v[8:9]
    v_pk_fma_f32 v[18:19], v[18:19], s[62:63], v[8:9]
    v_pk_fma_f32 v[20:21], v[20:21], s[62:63], v[8:9]
    v_pk_fma_f32 v[22:23], v[22:23], s[62:63], v[8:9]
    v_pk_mul_f32 v[16:17], v[16:17], v[184:185]
    v_pk_mul_f32 v[18:19], v[18:19], v[186:187]
    v_pk_mul_f32 v[20:21], v[20:21], v[188:189]
    v_pk_mul_f32 v[22:23], v[22:23], v[190:191]
    v_exp_f32 v16, v16
    v_exp_f32 v17, v17
    v_exp_f32 v18, v18
    v_exp_f32 v19, v19
    v_exp_f32 v20, v20
    v_exp_f32 v21, v21
    v_exp_f32 v22, v22
    v_exp_f32 v23, v23
    v_pk_mul_f32 v[184:185], v[184:185], v[228:229]
    v_pk_mul_f32 v[186:187], v[186:187], v[230:231]
    v_pk_mul_f32 v[188:189], v[188:189], v[228:229]
    v_pk_mul_f32 v[190:191], v[190:191], v[230:231]
    v_pk_add_f32 v[16:17], v[16:17], 1.0 op_sel_hi:[1,0]
    v_pk_add_f32 v[18:19], v[18:19], 1.0 op_sel_hi:[1,0]
    v_pk_add_f32 v[20:21], v[20:21], 1.0 op_sel_hi:[1,0]
    v_pk_add_f32 v[22:23], v[22:23], 1.0 op_sel_hi:[1,0]
    v_rcp_f32 v16, v16
    v_rcp_f32 v17, v17
    v_rcp_f32 v18, v18
    v_rcp_f32 v19, v19
    v_rcp_f32 v20, v20
    v_rcp_f32 v21, v21
    v_rcp_f32 v22, v22
    v_rcp_f32 v23, v23
    v_pk_fma_f32 v[240:241], v[176:177], v[24:25], v[240:241]
    v_pk_fma_f32 v[242:243], v[180:181], v[28:29], v[242:243]
    v_pk_fma_f32 v[240:241], v[178:179], v[26:27], v[240:241]
    v_pk_fma_f32 v[242:243], v[182:183], v[30:31], v[242:243]
    v_pk_mul_f32 v[24:25], v[192:193], v[192:193]
    v_pk_mul_f32 v[26:27], v[194:195], v[194:195]
    v_pk_mul_f32 v[28:29], v[196:197], v[196:197]
    v_pk_mul_f32 v[30:31], v[198:199], v[198:199]
    v_pk_fma_f32 v[24:25], v[24:25], s[62:63], v[8:9]
    v_pk_fma_f32 v[26:27], v[26:27], s[62:63], v[8:9]
    v_pk_fma_f32 v[28:29], v[28:29], s[62:63], v[8:9]
    v_pk_fma_f32 v[30:31], v[30:31], s[62:63], v[8:9]
    v_pk_mul_f32 v[24:25], v[24:25], v[192:193]
    v_pk_mul_f32 v[26:27], v[26:27], v[194:195]
    v_pk_mul_f32 v[28:29], v[28:29], v[196:197]
    v_pk_mul_f32 v[30:31], v[30:31], v[198:199]
    v_exp_f32 v24, v24
    v_exp_f32 v25, v25
    v_exp_f32 v26, v26
    v_exp_f32 v27, v27
    v_exp_f32 v28, v28
    v_exp_f32 v29, v29
    v_exp_f32 v30, v30
    v_exp_f32 v31, v31
    v_pk_mul_f32 v[192:193], v[192:193], v[228:229]
    v_pk_mul_f32 v[194:195], v[194:195], v[230:231]
    v_pk_mul_f32 v[196:197], v[196:197], v[228:229]
    v_pk_mul_f32 v[198:199], v[198:199], v[230:231]
    v_pk_add_f32 v[24:25], v[24:25], 1.0 op_sel_hi:[1,0]
    v_pk_add_f32 v[26:27], v[26:27], 1.0 op_sel_hi:[1,0]
    v_pk_add_f32 v[28:29], v[28:29], 1.0 op_sel_hi:[1,0]
    v_pk_add_f32 v[30:31], v[30:31], 1.0 op_sel_hi:[1,0]
    v_rcp_f32 v24, v24
    v_rcp_f32 v25, v25
    v_rcp_f32 v26, v26
    v_rcp_f32 v27, v27
    v_rcp_f32 v28, v28
    v_rcp_f32 v29, v29
    v_rcp_f32 v30, v30
    v_rcp_f32 v31, v31
    v_pk_fma_f32 v[236:237], v[184:185], v[16:17], v[236:237]
    v_pk_fma_f32 v[238:239], v[188:189], v[20:21], v[238:239]
    v_pk_fma_f32 v[236:237], v[186:187], v[18:19], v[236:237]
    v_pk_fma_f32 v[238:239], v[190:191], v[22:23], v[238:239]
    v_pk_mul_f32 v[16:17], v[200:201], v[200:201]
    v_pk_mul_f32 v[18:19], v[202:203], v[202:203]
    v_pk_mul_f32 v[20:21], v[204:205], v[204:205]
    v_pk_mul_f32 v[22:23], v[206:207], v[206:207]
    v_pk_fma_f32 v[16:17], v[16:17], s[62:63], v[8:9]
    v_pk_fma_f32 v[18:19], v[18:19], s[62:63], v[8:9]
    v_pk_fma_f32 v[20:21], v[20:21], s[62:63], v[8:9]
    v_pk_fma_f32 v[22:23], v[22:23], s[62:63], v[8:9]
    v_pk_mul_f32 v[16:17], v[16:17], v[200:201]
    v_pk_mul_f32 v[18:19], v[18:19], v[202:203]
    v_pk_mul_f32 v[20:21], v[20:21], v[204:205]
    v_pk_mul_f32 v[22:23], v[22:23], v[206:207]
    v_exp_f32 v16, v16
    v_exp_f32 v17, v17
    v_exp_f32 v18, v18
    v_exp_f32 v19, v19
    v_exp_f32 v20, v20
    v_exp_f32 v21, v21
    v_exp_f32 v22, v22
    v_exp_f32 v23, v23
    v_pk_mul_f32 v[200:201], v[200:201], v[232:233]
    v_pk_mul_f32 v[202:203], v[202:203], v[234:235]
    v_pk_mul_f32 v[204:205], v[204:205], v[232:233]
    v_pk_mul_f32 v[206:207], v[206:207], v[234:235]
    v_pk_add_f32 v[16:17], v[16:17], 1.0 op_sel_hi:[1,0]
    v_pk_add_f32 v[18:19], v[18:19], 1.0 op_sel_hi:[1,0]
    v_pk_add_f32 v[20:21], v[20:21], 1.0 op_sel_hi:[1,0]
    v_pk_add_f32 v[22:23], v[22:23], 1.0 op_sel_hi:[1,0]
    v_rcp_f32 v16, v16
    v_rcp_f32 v17, v17
    v_rcp_f32 v18, v18
    v_rcp_f32 v19, v19
    v_rcp_f32 v20, v20
    v_rcp_f32 v21, v21
    v_rcp_f32 v22, v22
    v_rcp_f32 v23, v23
    v_pk_fma_f32 v[240:241], v[192:193], v[24:25], v[240:241]
    v_pk_fma_f32 v[242:243], v[196:197], v[28:29], v[242:243]
    v_pk_fma_f32 v[240:241], v[194:195], v[26:27], v[240:241]
    v_pk_fma_f32 v[242:243], v[198:199], v[30:31], v[242:243]
    s_nop 0
    v_pk_fma_f32 v[236:237], v[200:201], v[16:17], v[236:237]
    v_pk_fma_f32 v[238:239], v[204:205], v[20:21], v[238:239]
    v_pk_fma_f32 v[236:237], v[202:203], v[18:19], v[236:237]
    v_pk_fma_f32 v[238:239], v[206:207], v[22:23], v[238:239]
    v_add_f32 v236, v236, v237
    v_add_f32 v240, v240, v241
    v_add_f32 v238, v238, v239
    v_add_f32 v242, v242, v243
    v_permlane32_swap_b32 v236, v240
    s_nop 0
    v_permlane32_swap_b32 v238, v242
    v_add_f32 v236, v236, v240
    v_add_f32 v238, v238, v242
    s_nop 1
    v_permlane16_swap_b32 v236, v238
    v_add_f32 v236, v236, v238
    buffer_store_dword v236, v244, s[44:47], 0 offen sc1
L_end:
    s_endpgm
L_codeend:
.section .rodata,"a"
.p2align 6
.amdhsa_kernel standalone__deep_cross_xdeepfm__recsys_kernel
  .amdhsa_next_free_vgpr 256
  .amdhsa_next_free_sgpr 102
  .amdhsa_accum_offset 256
  .amdhsa_group_segment_fixed_size 0
  .amdhsa_kernarg_size 88
  .amdhsa_user_sgpr_count 2
  .amdhsa_user_sgpr_kernarg_segment_ptr 1
  .amdhsa_system_sgpr_workgroup_id_x 1
  .amdhsa_float_denorm_mode_32 3
.end_amdhsa_kernel
```
